```python
import torch

def _softmax(x, axis=-1):
    return torch.softmax(x, dim=axis)

def _gelu(x):
    return torch.nn.functional.gelu(x, approximate='tanh')

def _silu(x):
    return torch.nn.functional.silu(x)

def _sigmoid(x):
    return torch.sigmoid(x)

def _layernorm(x, axis=-1, eps=1e-05):
    m = x.mean(dim=axis, keepdim=True)
    v = x.var(dim=axis, keepdim=True, unbiased=False)
    return (x - m) / torch.sqrt(v + eps)

def _scatter_add(tgt, idx, src, axis=0):
    return tgt.clone().index_add_(axis, idx, src)

def _segment_sum(src, seg, n):
    out = torch.zeros((n,) + src.shape[1:], dtype=src.dtype)
    return out.index_add_(0, seg, src)

def _pad(x, pw):
    flat = tuple((v for pair in reversed(pw) for v in pair))
    return torch.nn.functional.pad(x, flat)
kernel_name = 'adaLN_cond__gqa_block_cached__glu_gated_swiglu__decode'

def setup_inputs():

    _w = lambda a: (lambda t: t.to(torch.bfloat16) if t.is_floating_point() else t)(torch.as_tensor(a))

    def _A_setup():
        B, Sq, D = (4, 1, 1024)
        Hq, Hkv, Sk, Dh = (32, 4, 16384, 128)
        assert Hq % Hkv == 0, (Hq, Hkv)
        return {'x': _w((lambda *s: torch.randn(*s, dtype=torch.bfloat16) * 0.1)(B, Sq, D)), 'k_cache': _w((lambda *s: torch.randn(*s, dtype=torch.bfloat16) * 0.8)(B, Hkv, Sk, Dh)), 'v_cache': _w((lambda *s: torch.randn(*s, dtype=torch.bfloat16) * 3.2)(B, Hkv, Sk, Dh)), 'wq': _w((lambda *s: torch.randn(*s, dtype=torch.bfloat16) * 0.8)(D, Hq * Dh) * D ** (-0.5)), 'wo': _w((lambda *s: torch.randn(*s, dtype=torch.bfloat16) * 3.2)(Hq * Dh, D) * (Hq * Dh) ** (-0.5))}
    _A_in = _A_setup()

    def _B_setup():
        B, S, D, F = (4, 1, 1024, 3584)
        return {'x': _w((lambda *s: torch.randn(*s, dtype=torch.bfloat16) * 0.1)(B, S, D)), 'w1': _w((lambda *s: torch.randn(*s, dtype=torch.bfloat16) * 3.2)(D, F) * (2.0 / D) ** 0.5), 'w3': _w((lambda *s: torch.randn(*s, dtype=torch.bfloat16) * 3.2)(D, F) * (2.0 / D) ** 0.5), 'w2': _w((lambda *s: torch.randn(*s, dtype=torch.bfloat16) * 3.2)(F, D) * (2.0 / F) ** 0.5)}
    _B_in = _B_setup()
    return {'A_x': _A_in['x'], 'A_k_cache': _A_in['k_cache'], 'A_v_cache': _A_in['v_cache'], 'A_wq': _A_in['wq'], 'A_wo': _A_in['wo'], 'B_x': _B_in['x'], 'B_w1': _B_in['w1'], 'B_w3': _B_in['w3'], 'B_w2': _B_in['w2'], 'c': _w((lambda *s: torch.randn(*s, dtype=torch.bfloat16) * 0.2)(4, 1024) * 8.0), 'w_mod': _w((lambda *s: torch.randn(*s, dtype=torch.bfloat16) * 0.2)(1024, 6 * 1024) * 1024 ** (-0.5) * 8.0)}

def reference(A_x, A_k_cache, A_v_cache, A_wq, A_wo, B_x, B_w1, B_w3, B_w2, c, w_mod):

    def _A_ref(x, k_cache, v_cache, wq, wo):
        B, Sq, D = x.shape
        Hq, Dh = (32, 128)
        Hkv = k_cache.shape[1]
        rep = Hq // Hkv
        q = (lambda x, *d: x.permute(*d))((x @ wq).reshape(B, Sq, Hq, Dh), 0, 2, 1, 3)
        k = (lambda x, n, axis: torch.repeat_interleave(x, n, dim=axis))(k_cache, rep, axis=1)
        v = (lambda x, n, axis: torch.repeat_interleave(x, n, dim=axis))(v_cache, rep, axis=1)
        scores = torch.einsum('bhqd,bhkd->bhqk', q, k) * Dh ** (-0.5)
        p = _softmax(scores, axis=-1)
        o = torch.einsum('bhqk,bhkd->bhqd', p, v)
        return (lambda x, *d: x.permute(*d))(o, 0, 2, 1, 3).reshape(B, Sq, Hq * Dh) @ wo

    def _B_ref(x, w1, w3, w2):
        gate = torch.einsum('bsd,df->bsf', x, w1)
        up = torch.einsum('bsd,df->bsf', x, w3)
        h = _silu(gate) * up
        out = torch.einsum('bsf,fd->bsd', h, w2)
        return out
    x = A_x
    mod = (_silu(c) @ w_mod).reshape(c.shape[0], 6, 1, -1)
    sa, ca, ga, sb, cb, gb = (mod[:, 0].clone(), mod[:, 1].clone(), mod[:, 2].clone(), mod[:, 3].clone(), mod[:, 4].clone(), mod[:, 5].clone())
    h = _layernorm(x, axis=-1) * (1 + ca) + sa
    x = x + ga * _A_ref(h, A_k_cache, A_v_cache, A_wq, A_wo)
    h = _layernorm(x, axis=-1) * (1 + cb) + sb
    x = x + gb * _B_ref(h, B_w1, B_w3, B_w2)
    return x
```

```asm
; @launch grid=(256,1,1) block=(512,1,1) lds=150528
.amdgcn_target "amdgcn-amd-amdhsa--gfx950"
.text
.globl adaLN_cond__gqa_block_cached__glu_gated_swiglu__decode_kernel
.p2align 8
.type adaLN_cond__gqa_block_cached__glu_gated_swiglu__decode_kernel,@function
adaLN_cond__gqa_block_cached__glu_gated_swiglu__decode_kernel:
    s_cmp_ge_u32 s2, 256
    s_cbranch_scc1 L_exit
    s_load_dwordx16 s[4:19], s[0:1], 0
    s_getpc_b64 s[48:49]
L_pc:
    s_sub_u32 s48, s48, L_pc-adaLN_cond__gqa_block_cached__glu_gated_swiglu__decode_kernel
    s_subb_u32 s49, s49, 0
    s_lshl_b32 s40, s2, 4
    s_add_u32 s40, s40, role_table-adaLN_cond__gqa_block_cached__glu_gated_swiglu__decode_kernel
    s_load_dwordx4 s[92:95], s[48:49], s40
    s_load_dwordx8 s[20:27], s[0:1], 64
    s_load_dwordx4 s[28:31], s[0:1], 96
    v_lshrrev_b32 v2, 6, v0
    v_and_b32 v1, 63, v0
    v_readfirstlane_b32 s3, v2
    v_lshlrev_b32 v3, 7, v0
    s_cmp_ge_u32 s3, 5
    s_nop 1
    s_cbranch_scc1 L_nopf
    global_load_dword v255, v3, s[48:49]
L_nopf:
    s_cmp_ge_u32 s3, 4
    s_cbranch_scc1 L_aux
L_stream:
    v_lshrrev_b32 v12, 4, v1
    v_and_b32 v29, 15, v1
    v_lshlrev_b32 v34, 1, v12
    v_xor_b32 v34, v34, v29
    v_lshlrev_b32 v10, 4, v34
    v_xor_b32 v11, 128, v10
    v_and_b32 v45, 2, v12
    v_lshlrev_b32 v45, 1, v45
    v_and_or_b32 v45, v12, 1, v45
    s_lshl_b32 s32, s3, 15
    s_mov_b32 s55, 0x20000
    s_mov_b32 s96, 0
    s_lshl_b32 s43, s3, 6
    s_waitcnt lgkmcnt(0)
    s_mov_b32 s34, s92
    s_mov_b32 s35, s95
    s_lshr_b32 s15, s93, 25
    s_cmp_eq_u32 s15, 0
    s_cbranch_scc1 L_go
    s_barrier
L_go:
    s_cmp_eq_u32 s35, 8192
    s_cselect_b32 s52, s10, s24
    s_cselect_b32 s53, s11, s25
    s_mov_b32 s54, 12582912
    s_cselect_b32 s54, 8388608, s54
    s_mov_b32 s56, s35
    s_mul_i32 s58, s43, s35
    s_add_u32 s58, s58, s34
    s_mov_b32 s57, s58
    v_mov_b32 v36, v45
    s_mov_b32 s41, 1
    v_mad_u32_u24 v8, v36, s56, v10
    v_mad_u32_u24 v9, v36, s56, v11
    s_lshl_b32 s61, s56, s41
    s_lshl_b32 s60, s61, 3
    s_sub_u32 s60, s60, 1024
    s_lshl_b32 s61, s61, 2
    s_mov_b32 s41, s57
    s_add_u32 m0, s32, 0
    s_nop 0
    buffer_load_dwordx4 v8, s[52:55], s41 offen offset:0 nt lds
    s_add_u32 s41, s41, s60
    buffer_load_dwordx4 v9, s[52:55], s41 offen offset:1024 nt lds
    s_add_u32 s41, s41, s60
    buffer_load_dwordx4 v8, s[52:55], s41 offen offset:2048 nt lds
    s_add_u32 s41, s41, s60
    buffer_load_dwordx4 v9, s[52:55], s41 offen offset:3072 nt lds
    s_and_b32 s37, s2, 15
    s_lshr_b32 s38, s2, 4
    s_and_b32 s99, s93, 255
    s_cmp_ge_u32 s99, 64
    s_cselect_b32 s33, 1, 0
    s_cmp_ge_u32 s99, 192
    s_cselect_b32 s33, 2, s33
    s_bfe_u32 s36, s93, 0x20008
    s_bfe_u32 s39, s93, 0x6000a
    s_bfe_u32 s101, s93, 0x80010
    s_bfe_u32 s0, s93, 0x10018
    s_and_b32 s63, s94, 255
    s_bfe_u32 s1, s94, 0x80008
    s_lshr_b32 s14, s94, 16
    s_add_u32 s41, s57, s61
    s_add_u32 m0, s32, 4096
    s_nop 0
    buffer_load_dwordx4 v8, s[52:55], s41 offen offset:0 nt lds
    s_add_u32 s41, s41, s60
    buffer_load_dwordx4 v9, s[52:55], s41 offen offset:1024 nt lds
    s_add_u32 s41, s41, s60
    buffer_load_dwordx4 v8, s[52:55], s41 offen offset:2048 nt lds
    s_add_u32 s41, s41, s60
    buffer_load_dwordx4 v9, s[52:55], s41 offen offset:3072 nt lds
    s_lshl_b32 s40, s35, 1
    s_add_u32 s57, s58, s40
    v_mov_b32 v36, v45
    s_mov_b32 s41, 1
    v_mad_u32_u24 v8, v36, s56, v10
    v_mad_u32_u24 v9, v36, s56, v11
    s_lshl_b32 s61, s56, s41
    s_lshl_b32 s60, s61, 3
    s_sub_u32 s60, s60, 1024
    s_lshl_b32 s61, s61, 2
    s_mov_b32 s41, s57
    s_add_u32 m0, s32, 8192
    s_nop 0
    buffer_load_dwordx4 v8, s[52:55], s41 offen offset:0 nt lds
    s_add_u32 s41, s41, s60
    buffer_load_dwordx4 v9, s[52:55], s41 offen offset:1024 nt lds
    s_add_u32 s41, s41, s60
    buffer_load_dwordx4 v8, s[52:55], s41 offen offset:2048 nt lds
    s_add_u32 s41, s41, s60
    buffer_load_dwordx4 v9, s[52:55], s41 offen offset:3072 nt lds
    s_add_u32 s41, s57, s61
    s_add_u32 m0, s32, 12288
    s_nop 0
    buffer_load_dwordx4 v8, s[52:55], s41 offen offset:0 nt lds
    s_add_u32 s41, s41, s60
    buffer_load_dwordx4 v9, s[52:55], s41 offen offset:1024 nt lds
    s_add_u32 s41, s41, s60
    buffer_load_dwordx4 v8, s[52:55], s41 offen offset:2048 nt lds
    s_add_u32 s41, s41, s60
    buffer_load_dwordx4 v9, s[52:55], s41 offen offset:3072 nt lds
    s_mov_b32 s44, s6
    s_mov_b32 s45, s7
    s_mov_b32 s46, 67108864
    s_mov_b32 s47, 0x20000
    s_mov_b32 s48, s8
    s_mov_b32 s49, s9
    s_mov_b32 s50, 67108864
    s_mov_b32 s51, 0x20000
    s_lshl_b32 s62, s37, 22
    s_lshl_b32 s40, s38, 18
    s_add_u32 s62, s62, s40
    s_lshl_b32 s40, s3, 12
    s_add_u32 s62, s62, s40
    v_xor_b32 v34, v29, v12
    v_lshlrev_b32 v35, 8, v12
    v_lshl_add_u32 v2, v34, 4, v35
    v_xor_b32 v3, 64, v2
    v_xor_b32 v4, 128, v2
    v_xor_b32 v5, 192, v2
    v_add_u32 v6, v10, v35
    v_add_u32 v7, v11, v35
    v_lshlrev_b32 v35, 8, v29
    v_lshl_add_u32 v16, v34, 4, v35
    v_add_u32 v16, s32, v16
    v_xor_b32 v17, 64, v16
    v_xor_b32 v18, 128, v16
    v_xor_b32 v19, 192, v16
    v_lshrrev_b32 v30, 2, v1
    v_and_b32 v33, 3, v1
    v_lshlrev_b32 v34, 8, v30
    v_and_b32 v35, 7, v30
    v_lshl_add_u32 v34, v35, 5, v34
    v_lshl_add_u32 v34, v33, 3, v34
    v_add_u32 v20, s32, v34
    v_xor_b32 v21, 32, v20
    v_xor_b32 v22, 64, v20
    v_xor_b32 v23, 96, v20
    v_xor_b32 v24, 128, v20
    v_xor_b32 v25, 160, v20
    v_xor_b32 v26, 192, v20
    v_xor_b32 v27, 224, v20
    v_mov_b32 v13, 150272
    v_mov_b32 v14, 1
    s_cmp_lg_u32 s15, 0
    s_cbranch_scc1 L_go2
    s_barrier
L_go2:
    s_mov_b32 s52, s12
    s_mov_b32 s53, s13
    s_mov_b32 s54, 8388608
    s_mov_b32 s56, 2048
    s_and_b32 s40, s14, 7
    s_lshl_b32 s57, s40, 18
    s_lshl_b32 s40, s3, 21
    s_add_u32 s57, s57, s40
    s_bfe_u32 s40, s14, 0x20003
    s_lshl_b32 s40, s40, 16
    s_add_u32 s57, s57, s40
    s_lshr_b32 s40, s14, 5
    s_lshl_b32 s40, s40, 8
    s_add_u32 s57, s57, s40
    v_mov_b32 v36, v12
    s_mov_b32 s41, 0
    v_mad_u32_u24 v8, v36, s56, v10
    v_mad_u32_u24 v9, v36, s56, v11
    s_lshl_b32 s61, s56, s41
    s_lshl_b32 s60, s61, 3
    s_sub_u32 s60, s60, 1024
    s_lshl_b32 s61, s61, 2
    s_mov_b32 s41, s57
    s_add_u32 m0, s32, 16384
    s_waitcnt vmcnt(8)
    s_cmp_lg_u32 s96, 0
    s_cbranch_scc1 Lw_1
    s_waitcnt vmcnt(6)
Lw_1:
    buffer_load_dwordx4 v8, s[52:55], s41 offen offset:0 nt lds
    s_add_u32 s41, s41, s60
    buffer_load_dwordx4 v9, s[52:55], s41 offen offset:1024 nt lds
    s_add_u32 s41, s41, s60
    s_waitcnt vmcnt(8)
    s_cmp_lg_u32 s96, 0
    s_cbranch_scc1 Lw_2
    s_waitcnt vmcnt(6)
Lw_2:
    buffer_load_dwordx4 v8, s[52:55], s41 offen offset:2048 nt lds
    s_add_u32 s41, s41, s60
    buffer_load_dwordx4 v9, s[52:55], s41 offen offset:3072 nt lds
    s_waitcnt vmcnt(4)
    s_mov_b64 exec, 1
    ds_add_u32 v13, v14 offset:0
    s_mov_b64 exec, -1
    s_add_u32 s41, s57, s61
    s_add_u32 m0, s32, 20480
    s_nop 0
    buffer_load_dwordx4 v8, s[52:55], s41 offen offset:0 nt lds
    s_add_u32 s41, s41, s60
    buffer_load_dwordx4 v9, s[52:55], s41 offen offset:1024 nt lds
    s_add_u32 s41, s41, s60
    buffer_load_dwordx4 v8, s[52:55], s41 offen offset:2048 nt lds
    s_add_u32 s41, s41, s60
    buffer_load_dwordx4 v9, s[52:55], s41 offen offset:3072 nt lds
    s_lshr_b32 s40, s1, 3
    s_lshl_b32 s57, s40, 18
    s_lshl_b32 s40, s3, 16
    s_add_u32 s57, s57, s40
    s_and_b32 s40, s1, 7
    s_lshl_b32 s40, s40, 8
    s_add_u32 s57, s57, s40
    s_mov_b32 s52, s20
    s_mov_b32 s53, s21
    s_cmp_lt_u32 s99, 224
    s_cselect_b32 s54, 7340032, 0
    s_mov_b32 s56, 2048
    v_mov_b32 v36, v12
    s_mov_b32 s41, 0
    v_mad_u32_u24 v8, v36, s56, v10
    v_mad_u32_u24 v9, v36, s56, v11
    s_lshl_b32 s61, s56, s41
    s_lshl_b32 s60, s61, 3
    s_sub_u32 s60, s60, 1024
    s_lshl_b32 s61, s61, 2
    s_mov_b32 s41, s57
    s_add_u32 m0, s32, 24576
    s_cmp_lg_u32 s96, 0
    s_cbranch_scc1 Lw_3
    s_waitcnt vmcnt(6)
Lw_3:
    buffer_load_dwordx4 v8, s[52:55], s41 offen offset:0 nt lds
    s_add_u32 s41, s41, s60
    buffer_load_dwordx4 v9, s[52:55], s41 offen offset:1024 nt lds
    s_add_u32 s41, s41, s60
    s_waitcnt vmcnt(8)
    s_cmp_lg_u32 s96, 0
    s_cbranch_scc1 Lw_4
    s_waitcnt vmcnt(6)
Lw_4:
    buffer_load_dwordx4 v8, s[52:55], s41 offen offset:2048 nt lds
    s_add_u32 s41, s41, s60
    buffer_load_dwordx4 v9, s[52:55], s41 offen offset:3072 nt lds
    s_add_u32 s41, s57, s61
    s_add_u32 m0, s32, 28672
    s_waitcnt vmcnt(8)
    s_cmp_lg_u32 s96, 0
    s_cbranch_scc1 Lw_5
    s_waitcnt vmcnt(6)
Lw_5:
    buffer_load_dwordx4 v8, s[52:55], s41 offen offset:0 nt lds
    s_add_u32 s41, s41, s60
    buffer_load_dwordx4 v9, s[52:55], s41 offen offset:1024 nt lds
    s_add_u32 s41, s41, s60
    s_waitcnt vmcnt(8)
    s_cmp_lg_u32 s96, 0
    s_cbranch_scc1 Lw_6
    s_waitcnt vmcnt(6)
Lw_6:
    buffer_load_dwordx4 v8, s[52:55], s41 offen offset:2048 nt lds
    s_add_u32 s41, s41, s60
    buffer_load_dwordx4 v9, s[52:55], s41 offen offset:3072 nt lds
    s_mov_b32 s41, 0
Lsp_7:
    ds_read_b32 v15, v13 offset:32
    s_add_u32 s41, s41, 1
    s_waitcnt lgkmcnt(0)
    v_readfirstlane_b32 s40, v15
    s_nop 0
    s_cmp_ge_u32 s40, 4
    s_nop 1
    s_cbranch_scc1 Lspd_8
    s_cmp_lt_u32 s41, 131072
    s_cbranch_scc1 Lsp_7
Lspd_8:
    s_and_b32 s40, s101, 7
    s_lshl_b32 s40, s40, 2
    s_add_u32 s40, s40, s3
    s_mul_i32 s57, s40, 393216
    s_lshr_b32 s40, s101, 3
    s_lshl_b32 s40, s40, 8
    s_add_u32 s57, s57, s40
    s_add_u32 s57, s57, 10240
    s_mov_b32 s52, s24
    s_mov_b32 s53, s25
    s_cmp_lg_u32 s0, 0
    s_cselect_b32 s54, 12582912, 0
    s_mov_b32 s56, 12288
    v_mov_b32 v36, v12
    s_mov_b32 s41, 0
    v_mad_u32_u24 v8, v36, s56, v10
    v_mad_u32_u24 v9, v36, s56, v11
    s_lshl_b32 s61, s56, s41
    s_lshl_b32 s60, s61, 3
    s_sub_u32 s60, s60, 1024
    s_lshl_b32 s61, s61, 2
    s_mov_b32 s41, s57
    s_add_u32 m0, s32, 0
    s_waitcnt vmcnt(8)
    s_mov_b64 exec, 1
    ds_add_u32 v13, v14 offset:4
    s_mov_b64 exec, -1
    s_cmp_lg_u32 s96, 0
    s_cbranch_scc1 Lw_9
    s_waitcnt vmcnt(6)
Lw_9:
    buffer_load_dwordx4 v8, s[52:55], s41 offen offset:0 nt lds
    s_add_u32 s41, s41, s60
    buffer_load_dwordx4 v9, s[52:55], s41 offen offset:1024 nt lds
    s_add_u32 s41, s41, s60
    s_waitcnt vmcnt(8)
    s_cmp_lg_u32 s96, 0
    s_cbranch_scc1 Lw_10
    s_waitcnt vmcnt(6)
Lw_10:
    buffer_load_dwordx4 v8, s[52:55], s41 offen offset:2048 nt lds
    s_add_u32 s41, s41, s60
    buffer_load_dwordx4 v9, s[52:55], s41 offen offset:3072 nt lds
    s_add_u32 s41, s57, s61
    s_add_u32 m0, s32, 4096
    s_waitcnt vmcnt(8)
    s_cmp_lg_u32 s96, 0
    s_cbranch_scc1 Lw_11
    s_waitcnt vmcnt(6)
Lw_11:
    buffer_load_dwordx4 v8, s[52:55], s41 offen offset:0 nt lds
    s_add_u32 s41, s41, s60
    buffer_load_dwordx4 v9, s[52:55], s41 offen offset:1024 nt lds
    s_add_u32 s41, s41, s60
    s_waitcnt vmcnt(8)
    s_cmp_lg_u32 s96, 0
    s_cbranch_scc1 Lw_12
    s_waitcnt vmcnt(6)
Lw_12:
    buffer_load_dwordx4 v8, s[52:55], s41 offen offset:2048 nt lds
    s_add_u32 s41, s41, s60
    buffer_load_dwordx4 v9, s[52:55], s41 offen offset:3072 nt lds
    s_and_b32 s40, s63, 7
    s_lshl_b32 s40, s40, 2
    s_add_u32 s40, s40, s3
    s_mul_i32 s59, s40, 229376
    s_lshr_b32 s40, s63, 3
    s_lshl_b32 s40, s40, 8
    s_add_u32 s59, s59, s40
    s_sub_u32 s40, s101, s39
    s_lshl_b32 s40, s40, 8
    s_add_u32 s40, s40, s58
    s_add_u32 s40, s40, 0
    s_cmp_lt_u32 s99, 224
    s_cselect_b32 s52, s16, s24
    s_cselect_b32 s53, s17, s25
    s_mov_b32 s54, 12582912
    s_cselect_b32 s54, 7340032, s54
    s_mov_b32 s56, 12288
    s_cselect_b32 s56, 7168, s56
    s_cselect_b32 s57, s59, s40
    s_cselect_b64 vcc, 0, -1
    s_cselect_b32 s41, 0, 1
    v_cndmask_b32 v36, v12, v45, vcc
    v_mad_u32_u24 v8, v36, s56, v10
    v_mad_u32_u24 v9, v36, s56, v11
    s_lshl_b32 s61, s56, s41
    s_lshl_b32 s60, s61, 3
    s_sub_u32 s60, s60, 1024
    s_lshl_b32 s61, s61, 2
    s_mov_b32 s41, s57
    s_add_u32 m0, s32, 8192
    s_waitcnt vmcnt(8)
    s_mov_b64 exec, 1
    ds_add_u32 v13, v14 offset:16
    s_mov_b64 exec, -1
    s_cmp_lg_u32 s96, 0
    s_cbranch_scc1 Lw_13
    s_waitcnt vmcnt(6)
Lw_13:
    buffer_load_dwordx4 v8, s[52:55], s41 offen offset:0 nt lds
    s_add_u32 s41, s41, s60
    buffer_load_dwordx4 v9, s[52:55], s41 offen offset:1024 nt lds
    s_add_u32 s41, s41, s60
    s_waitcnt vmcnt(8)
    s_cmp_lg_u32 s96, 0
    s_cbranch_scc1 Lw_14
    s_waitcnt vmcnt(6)
Lw_14:
    buffer_load_dwordx4 v8, s[52:55], s41 offen offset:2048 nt lds
    s_add_u32 s41, s41, s60
    buffer_load_dwordx4 v9, s[52:55], s41 offen offset:3072 nt lds
    s_add_u32 s41, s57, s61
    s_add_u32 m0, s32, 12288
    s_waitcnt vmcnt(8)
    s_cmp_lg_u32 s96, 0
    s_cbranch_scc1 Lw_15
    s_waitcnt vmcnt(6)
Lw_15:
    buffer_load_dwordx4 v8, s[52:55], s41 offen offset:0 nt lds
    s_add_u32 s41, s41, s60
    buffer_load_dwordx4 v9, s[52:55], s41 offen offset:1024 nt lds
    s_add_u32 s41, s41, s60
    s_waitcnt vmcnt(8)
    s_cmp_lg_u32 s96, 0
    s_cbranch_scc1 Lw_16
    s_waitcnt vmcnt(6)
Lw_16:
    buffer_load_dwordx4 v8, s[52:55], s41 offen offset:2048 nt lds
    s_add_u32 s41, s41, s60
    buffer_load_dwordx4 v9, s[52:55], s41 offen offset:3072 nt lds
    s_mov_b32 s41, 0
Lsp_17:
    ds_read_b32 v15, v13 offset:36
    s_add_u32 s41, s41, 1
    s_waitcnt lgkmcnt(0)
    v_readfirstlane_b32 s40, v15
    s_nop 0
    s_cmp_ge_u32 s40, 4
    s_nop 1
    s_cbranch_scc1 Lspd_18
    s_cmp_lt_u32 s41, 131072
    s_cbranch_scc1 Lsp_17
Lspd_18:
    s_sub_u32 s40, s101, s39
    s_lshl_b32 s40, s40, 8
    s_add_u32 s40, s40, s58
    s_add_u32 s40, s40, 24576
    s_cmp_lt_u32 s99, 224
    s_cselect_b32 s52, s18, s24
    s_cselect_b32 s53, s19, s25
    s_mov_b32 s54, 12582912
    s_cselect_b32 s54, 7340032, s54
    s_mov_b32 s56, 12288
    s_cselect_b32 s56, 7168, s56
    s_cselect_b32 s57, s59, s40
    s_cselect_b64 vcc, 0, -1
    s_cselect_b32 s41, 0, 1
    v_cndmask_b32 v36, v12, v45, vcc
    v_mad_u32_u24 v8, v36, s56, v10
    v_mad_u32_u24 v9, v36, s56, v11
    s_lshl_b32 s61, s56, s41
    s_lshl_b32 s60, s61, 3
    s_sub_u32 s60, s60, 1024
    s_lshl_b32 s61, s61, 2
    s_mov_b32 s41, s57
    s_add_u32 m0, s32, 16384
    s_waitcnt vmcnt(8)
    s_mov_b64 exec, 1
    ds_add_u32 v13, v14 offset:20
    s_mov_b64 exec, -1
    s_cmp_lg_u32 s96, 0
    s_cbranch_scc1 Lw_19
    s_waitcnt vmcnt(6)
Lw_19:
    buffer_load_dwordx4 v8, s[52:55], s41 offen offset:0 nt lds
    s_add_u32 s41, s41, s60
    buffer_load_dwordx4 v9, s[52:55], s41 offen offset:1024 nt lds
    s_add_u32 s41, s41, s60
    s_waitcnt vmcnt(8)
    s_cmp_lg_u32 s96, 0
    s_cbranch_scc1 Lw_20
    s_waitcnt vmcnt(6)
Lw_20:
    buffer_load_dwordx4 v8, s[52:55], s41 offen offset:2048 nt lds
    s_add_u32 s41, s41, s60
    buffer_load_dwordx4 v9, s[52:55], s41 offen offset:3072 nt lds
    s_add_u32 s41, s57, s61
    s_add_u32 m0, s32, 20480
    s_waitcnt vmcnt(8)
    s_cmp_lg_u32 s96, 0
    s_cbranch_scc1 Lw_21
    s_waitcnt vmcnt(6)
Lw_21:
    buffer_load_dwordx4 v8, s[52:55], s41 offen offset:0 nt lds
    s_add_u32 s41, s41, s60
    buffer_load_dwordx4 v9, s[52:55], s41 offen offset:1024 nt lds
    s_add_u32 s41, s41, s60
    s_waitcnt vmcnt(8)
    s_cmp_lg_u32 s96, 0
    s_cbranch_scc1 Lw_22
    s_waitcnt vmcnt(6)
Lw_22:
    buffer_load_dwordx4 v8, s[52:55], s41 offen offset:2048 nt lds
    s_add_u32 s41, s41, s60
    buffer_load_dwordx4 v9, s[52:55], s41 offen offset:3072 nt lds
    s_mov_b32 s41, 0
Lsp_23:
    ds_read_b32 v15, v13 offset:48
    s_add_u32 s41, s41, 1
    s_waitcnt lgkmcnt(0)
    v_readfirstlane_b32 s40, v15
    s_nop 0
    s_cmp_ge_u32 s40, 4
    s_nop 1
    s_cbranch_scc1 Lspd_24
    s_cmp_lt_u32 s41, 131072
    s_cbranch_scc1 Lsp_23
Lspd_24:
    s_add_u32 s41, s62, 0
    s_add_u32 m0, s32, 24576
    s_waitcnt vmcnt(8)
    s_mov_b64 exec, 1
    ds_add_u32 v13, v14 offset:8
    s_mov_b64 exec, -1
    s_cmp_lg_u32 s96, 0
    s_cbranch_scc1 Lw_25
    s_waitcnt vmcnt(6)
Lw_25:
    buffer_load_dwordx4 v2, s[44:47], s41 offen offset:0 nt lds
    buffer_load_dwordx4 v3, s[44:47], s41 offen offset:1024 nt lds
    s_waitcnt vmcnt(8)
    s_cmp_lg_u32 s96, 0
    s_cbranch_scc1 Lw_26
    s_waitcnt vmcnt(6)
Lw_26:
    buffer_load_dwordx4 v4, s[44:47], s41 offen offset:2048 nt lds
    buffer_load_dwordx4 v5, s[44:47], s41 offen offset:3072 nt lds
    s_add_u32 s41, s62, 16384
    s_add_u32 m0, s32, 28672
    s_waitcnt vmcnt(8)
    s_cmp_lg_u32 s96, 0
    s_cbranch_scc1 Lw_27
    s_waitcnt vmcnt(6)
Lw_27:
    buffer_load_dwordx4 v2, s[44:47], s41 offen offset:0 nt lds
    buffer_load_dwordx4 v3, s[44:47], s41 offen offset:1024 nt lds
    s_waitcnt vmcnt(8)
    s_cmp_lg_u32 s96, 0
    s_cbranch_scc1 Lw_28
    s_waitcnt vmcnt(6)
Lw_28:
    buffer_load_dwordx4 v4, s[44:47], s41 offen offset:2048 nt lds
    buffer_load_dwordx4 v5, s[44:47], s41 offen offset:3072 nt lds
    s_mov_b32 s41, 0
Lsp_29:
    ds_read_b32 v15, v13 offset:52
    s_add_u32 s41, s41, 1
    s_waitcnt lgkmcnt(0)
    v_readfirstlane_b32 s40, v15
    s_nop 0
    s_cmp_ge_u32 s40, 4
    s_nop 1
    s_cbranch_scc1 Lspd_30
    s_cmp_lt_u32 s41, 131072
    s_cbranch_scc1 Lsp_29
Lspd_30:
    s_add_u32 s41, s62, 32768
    s_add_u32 m0, s32, 0
    s_waitcnt vmcnt(8)
    s_mov_b64 exec, 1
    ds_add_u32 v13, v14 offset:12
    s_mov_b64 exec, -1
    s_cmp_lg_u32 s96, 0
    s_cbranch_scc1 Lw_31
    s_waitcnt vmcnt(6)
Lw_31:
    buffer_load_dwordx4 v2, s[44:47], s41 offen offset:0 nt lds
    buffer_load_dwordx4 v3, s[44:47], s41 offen offset:1024 nt lds
    s_waitcnt vmcnt(8)
    s_cmp_lg_u32 s96, 0
    s_cbranch_scc1 Lw_32
    s_waitcnt vmcnt(6)
Lw_32:
    buffer_load_dwordx4 v4, s[44:47], s41 offen offset:2048 nt lds
    buffer_load_dwordx4 v5, s[44:47], s41 offen offset:3072 nt lds
    s_add_u32 s41, s62, 49152
    s_add_u32 m0, s32, 4096
    s_waitcnt vmcnt(8)
    s_cmp_lg_u32 s96, 0
    s_cbranch_scc1 Lw_33
    s_waitcnt vmcnt(6)
Lw_33:
    buffer_load_dwordx4 v2, s[44:47], s41 offen offset:0 nt lds
    buffer_load_dwordx4 v3, s[44:47], s41 offen offset:1024 nt lds
    s_waitcnt vmcnt(8)
    s_cmp_lg_u32 s96, 0
    s_cbranch_scc1 Lw_34
    s_waitcnt vmcnt(6)
Lw_34:
    buffer_load_dwordx4 v4, s[44:47], s41 offen offset:2048 nt lds
    buffer_load_dwordx4 v5, s[44:47], s41 offen offset:3072 nt lds
    s_mov_b32 s41, 0
Lsp_35:
    ds_read_b32 v15, v13 offset:40
    s_add_u32 s41, s41, 1
    s_waitcnt lgkmcnt(0)
    v_readfirstlane_b32 s40, v15
    s_nop 0
    s_cmp_ge_u32 s40, 4
    s_nop 1
    s_cbranch_scc1 Lspd_36
    s_cmp_lt_u32 s41, 131072
    s_cbranch_scc1 Lsp_35
Lspd_36:
    s_add_u32 s41, s62, 65536
    s_add_u32 m0, s32, 8192
    s_waitcnt vmcnt(8)
    s_cmp_lg_u32 s96, 0
    s_cbranch_scc1 Lw_37
    s_waitcnt vmcnt(6)
Lw_37:
    buffer_load_dwordx4 v2, s[44:47], s41 offen offset:0 nt lds
    buffer_load_dwordx4 v3, s[44:47], s41 offen offset:1024 nt lds
    s_waitcnt vmcnt(8)
    s_cmp_lg_u32 s96, 0
    s_cbranch_scc1 Lw_38
    s_waitcnt vmcnt(6)
Lw_38:
    buffer_load_dwordx4 v4, s[44:47], s41 offen offset:2048 nt lds
    buffer_load_dwordx4 v5, s[44:47], s41 offen offset:3072 nt lds
    s_add_u32 s41, s62, 81920
    s_add_u32 m0, s32, 12288
    s_waitcnt vmcnt(8)
    s_cmp_lg_u32 s96, 0
    s_cbranch_scc1 Lw_39
    s_waitcnt vmcnt(6)
Lw_39:
    buffer_load_dwordx4 v2, s[44:47], s41 offen offset:0 nt lds
    buffer_load_dwordx4 v3, s[44:47], s41 offen offset:1024 nt lds
    s_waitcnt vmcnt(8)
    s_cmp_lg_u32 s96, 0
    s_cbranch_scc1 Lw_40
    s_waitcnt vmcnt(6)
Lw_40:
    buffer_load_dwordx4 v4, s[44:47], s41 offen offset:2048 nt lds
    buffer_load_dwordx4 v5, s[44:47], s41 offen offset:3072 nt lds
    s_mov_b32 s41, 0
Lsp_41:
    ds_read_b32 v15, v13 offset:44
    s_add_u32 s41, s41, 1
    s_waitcnt lgkmcnt(0)
    v_readfirstlane_b32 s40, v15
    s_nop 0
    s_cmp_ge_u32 s40, 4
    s_nop 1
    s_cbranch_scc1 Lspd_42
    s_cmp_lt_u32 s41, 131072
    s_cbranch_scc1 Lsp_41
Lspd_42:
    s_add_u32 s41, s62, 98304
    s_add_u32 m0, s32, 16384
    s_waitcnt vmcnt(8)
    s_cmp_lg_u32 s96, 0
    s_cbranch_scc1 Lw_43
    s_waitcnt vmcnt(6)
Lw_43:
    buffer_load_dwordx4 v2, s[44:47], s41 offen offset:0 nt lds
    buffer_load_dwordx4 v3, s[44:47], s41 offen offset:1024 nt lds
    s_waitcnt vmcnt(8)
    s_cmp_lg_u32 s96, 0
    s_cbranch_scc1 Lw_44
    s_waitcnt vmcnt(6)
Lw_44:
    buffer_load_dwordx4 v4, s[44:47], s41 offen offset:2048 nt lds
    buffer_load_dwordx4 v5, s[44:47], s41 offen offset:3072 nt lds
    s_mov_b64 exec, 1
    ds_add_u32 v13, v14 offset:96
    s_mov_b64 exec, -1
    s_add_u32 s41, s62, 114688
    s_add_u32 m0, s32, 20480
    s_waitcnt vmcnt(8)
    s_cmp_lg_u32 s96, 0
    s_cbranch_scc1 Lw_45
    s_waitcnt vmcnt(6)
Lw_45:
    buffer_load_dwordx4 v2, s[44:47], s41 offen offset:0 nt lds
    buffer_load_dwordx4 v3, s[44:47], s41 offen offset:1024 nt lds
    s_waitcnt vmcnt(8)
    s_cmp_lg_u32 s96, 0
    s_cbranch_scc1 Lw_46
    s_waitcnt vmcnt(6)
Lw_46:
    buffer_load_dwordx4 v4, s[44:47], s41 offen offset:2048 nt lds
    buffer_load_dwordx4 v5, s[44:47], s41 offen offset:3072 nt lds
    ds_read_b128 v[128:131], v16 offset:24576
    ds_read_b128 v[132:135], v17 offset:24576
    ds_read_b128 v[136:139], v18 offset:24576
    ds_read_b128 v[140:143], v19 offset:24576
    s_waitcnt lgkmcnt(0)
    s_add_u32 s41, s62, 131072
    s_add_u32 m0, s32, 24576
    s_waitcnt vmcnt(8)
    s_cmp_lg_u32 s96, 0
    s_cbranch_scc1 Lw_47
    s_waitcnt vmcnt(6)
Lw_47:
    buffer_load_dwordx4 v2, s[44:47], s41 offen offset:0 nt lds
    buffer_load_dwordx4 v3, s[44:47], s41 offen offset:1024 nt lds
    s_waitcnt vmcnt(8)
    s_cmp_lg_u32 s96, 0
    s_cbranch_scc1 Lw_48
    s_waitcnt vmcnt(6)
Lw_48:
    buffer_load_dwordx4 v4, s[44:47], s41 offen offset:2048 nt lds
    buffer_load_dwordx4 v5, s[44:47], s41 offen offset:3072 nt lds
    ds_read_b128 v[144:147], v16 offset:28672
    ds_read_b128 v[148:151], v17 offset:28672
    ds_read_b128 v[152:155], v18 offset:28672
    ds_read_b128 v[156:159], v19 offset:28672
    s_waitcnt lgkmcnt(0)
    s_add_u32 s41, s62, 147456
    s_add_u32 m0, s32, 28672
    s_waitcnt vmcnt(8)
    s_cmp_lg_u32 s96, 0
    s_cbranch_scc1 Lw_49
    s_waitcnt vmcnt(6)
Lw_49:
    buffer_load_dwordx4 v2, s[44:47], s41 offen offset:0 nt lds
    buffer_load_dwordx4 v3, s[44:47], s41 offen offset:1024 nt lds
    s_waitcnt vmcnt(8)
    s_cmp_lg_u32 s96, 0
    s_cbranch_scc1 Lw_50
    s_waitcnt vmcnt(6)
Lw_50:
    buffer_load_dwordx4 v4, s[44:47], s41 offen offset:2048 nt lds
    buffer_load_dwordx4 v5, s[44:47], s41 offen offset:3072 nt lds
    ds_read_b128 v[160:163], v16 offset:0
    ds_read_b128 v[164:167], v17 offset:0
    ds_read_b128 v[168:171], v18 offset:0
    ds_read_b128 v[172:175], v19 offset:0
    s_waitcnt lgkmcnt(0)
    s_add_u32 s41, s62, 163840
    s_add_u32 m0, s32, 0
    s_waitcnt vmcnt(8)
    s_cmp_lg_u32 s96, 0
    s_cbranch_scc1 Lw_51
    s_waitcnt vmcnt(6)
Lw_51:
    buffer_load_dwordx4 v2, s[44:47], s41 offen offset:0 nt lds
    buffer_load_dwordx4 v3, s[44:47], s41 offen offset:1024 nt lds
    s_waitcnt vmcnt(8)
    s_cmp_lg_u32 s96, 0
    s_cbranch_scc1 Lw_52
    s_waitcnt vmcnt(6)
Lw_52:
    buffer_load_dwordx4 v4, s[44:47], s41 offen offset:2048 nt lds
    buffer_load_dwordx4 v5, s[44:47], s41 offen offset:3072 nt lds
    ds_read_b128 v[176:179], v16 offset:4096
    ds_read_b128 v[180:183], v17 offset:4096
    ds_read_b128 v[184:187], v18 offset:4096
    ds_read_b128 v[188:191], v19 offset:4096
    s_waitcnt lgkmcnt(0)
    s_add_u32 s41, s62, 180224
    s_add_u32 m0, s32, 4096
    s_waitcnt vmcnt(8)
    s_cmp_lg_u32 s96, 0
    s_cbranch_scc1 Lw_53
    s_waitcnt vmcnt(6)
Lw_53:
    buffer_load_dwordx4 v2, s[44:47], s41 offen offset:0 nt lds
    buffer_load_dwordx4 v3, s[44:47], s41 offen offset:1024 nt lds
    s_waitcnt vmcnt(8)
    s_cmp_lg_u32 s96, 0
    s_cbranch_scc1 Lw_54
    s_waitcnt vmcnt(6)
Lw_54:
    buffer_load_dwordx4 v4, s[44:47], s41 offen offset:2048 nt lds
    buffer_load_dwordx4 v5, s[44:47], s41 offen offset:3072 nt lds
    s_mov_b64 exec, 1
    ds_add_u32 v13, v14 offset:88
    s_mov_b64 exec, -1
    ds_read_b128 v[192:195], v16 offset:8192
    ds_read_b128 v[196:199], v17 offset:8192
    ds_read_b128 v[200:203], v18 offset:8192
    ds_read_b128 v[204:207], v19 offset:8192
    s_waitcnt lgkmcnt(0)
    s_add_u32 s41, s62, 196608
    s_add_u32 m0, s32, 8192
    s_waitcnt vmcnt(8)
    s_cmp_lg_u32 s96, 0
    s_cbranch_scc1 Lw_55
    s_waitcnt vmcnt(6)
Lw_55:
    buffer_load_dwordx4 v2, s[44:47], s41 offen offset:0 nt lds
    buffer_load_dwordx4 v3, s[44:47], s41 offen offset:1024 nt lds
    s_waitcnt vmcnt(8)
    s_cmp_lg_u32 s96, 0
    s_cbranch_scc1 Lw_56
    s_waitcnt vmcnt(6)
Lw_56:
    buffer_load_dwordx4 v4, s[44:47], s41 offen offset:2048 nt lds
    buffer_load_dwordx4 v5, s[44:47], s41 offen offset:3072 nt lds
    ds_read_b128 v[208:211], v16 offset:12288
    ds_read_b128 v[212:215], v17 offset:12288
    ds_read_b128 v[216:219], v18 offset:12288
    ds_read_b128 v[220:223], v19 offset:12288
    s_waitcnt lgkmcnt(0)
    s_add_u32 s41, s62, 212992
    s_add_u32 m0, s32, 12288
    s_waitcnt vmcnt(8)
    s_cmp_lg_u32 s96, 0
    s_cbranch_scc1 Lw_57
    s_waitcnt vmcnt(6)
Lw_57:
    buffer_load_dwordx4 v2, s[44:47], s41 offen offset:0 nt lds
    buffer_load_dwordx4 v3, s[44:47], s41 offen offset:1024 nt lds
    s_waitcnt vmcnt(8)
    s_cmp_lg_u32 s96, 0
    s_cbranch_scc1 Lw_58
    s_waitcnt vmcnt(6)
Lw_58:
    buffer_load_dwordx4 v4, s[44:47], s41 offen offset:2048 nt lds
    buffer_load_dwordx4 v5, s[44:47], s41 offen offset:3072 nt lds
    ds_read_b128 v[224:227], v16 offset:16384
    ds_read_b128 v[228:231], v17 offset:16384
    ds_read_b128 v[232:235], v18 offset:16384
    ds_read_b128 v[236:239], v19 offset:16384
    s_waitcnt lgkmcnt(0)
    s_add_u32 s41, s62, 229376
    s_add_u32 m0, s32, 16384
    s_waitcnt vmcnt(8)
    s_cmp_lg_u32 s96, 0
    s_cbranch_scc1 Lw_59
    s_waitcnt vmcnt(6)
Lw_59:
    buffer_load_dwordx4 v2, s[44:47], s41 offen offset:0 nt lds
    buffer_load_dwordx4 v3, s[44:47], s41 offen offset:1024 nt lds
    s_waitcnt vmcnt(8)
    s_cmp_lg_u32 s96, 0
    s_cbranch_scc1 Lw_60
    s_waitcnt vmcnt(6)
Lw_60:
    buffer_load_dwordx4 v4, s[44:47], s41 offen offset:2048 nt lds
    buffer_load_dwordx4 v5, s[44:47], s41 offen offset:3072 nt lds
    ds_read_b128 v[240:243], v16 offset:20480
    ds_read_b128 v[244:247], v17 offset:20480
    ds_read_b128 v[248:251], v18 offset:20480
    ds_read_b128 v[252:255], v19 offset:20480
    s_waitcnt lgkmcnt(0)
    s_add_u32 s41, s62, 245760
    s_add_u32 m0, s32, 20480
    s_waitcnt vmcnt(8)
    s_cmp_lg_u32 s96, 0
    s_cbranch_scc1 Lw_61
    s_waitcnt vmcnt(6)
Lw_61:
    buffer_load_dwordx4 v2, s[44:47], s41 offen offset:0 nt lds
    buffer_load_dwordx4 v3, s[44:47], s41 offen offset:1024 nt lds
    s_waitcnt vmcnt(8)
    s_cmp_lg_u32 s96, 0
    s_cbranch_scc1 Lw_62
    s_waitcnt vmcnt(6)
Lw_62:
    buffer_load_dwordx4 v4, s[44:47], s41 offen offset:2048 nt lds
    buffer_load_dwordx4 v5, s[44:47], s41 offen offset:3072 nt lds
    s_mov_b32 s41, 0
Lsp_63:
    ds_read_b32 v15, v13 offset:64
    s_add_u32 s41, s41, 1
    s_waitcnt lgkmcnt(0)
    v_readfirstlane_b32 s40, v15
    s_nop 0
    s_cmp_ge_u32 s40, 4
    s_nop 1
    s_cbranch_scc1 Lspd_64
    s_cmp_lt_u32 s41, 131072
    s_cbranch_scc1 Lsp_63
Lspd_64:
    v_and_b32 v34, 7, v1
    v_mul_u32_u24 v34, 272, v34
    v_lshl_add_u32 v34, v12, 4, v34
    v_add_u32 v34, 147456, v34
    s_mov_b32 s42, 0x3db504f3
    s_mov_b32 s43, 0x3fb8aa3b
    ds_read_b128 v[48:51], v34 offset:0
    ds_read_b128 v[52:55], v34 offset:64
    ds_read_b128 v[56:59], v34 offset:128
    ds_read_b128 v[60:63], v34 offset:192
    s_waitcnt lgkmcnt(0)
    s_mov_b32 s96, 0
    v_mfma_f32_16x16x32_bf16 v[64:67], v[128:131], v[48:51], 0
    v_mfma_f32_16x16x32_bf16 v[64:67], v[132:135], v[52:55], v[64:67]
    v_mfma_f32_16x16x32_bf16 v[64:67], v[136:139], v[56:59], v[64:67]
    v_mfma_f32_16x16x32_bf16 v[64:67], v[140:143], v[60:63], v[64:67]
    ds_read_b128 v[128:131], v16 offset:24576
    ds_read_b128 v[132:135], v17 offset:24576
    ds_read_b128 v[136:139], v18 offset:24576
    ds_read_b128 v[140:143], v19 offset:24576
    s_waitcnt lgkmcnt(0)
    s_add_u32 s41, s62, 0
    s_add_u32 m0, s32, 24576
    s_waitcnt vmcnt(8)
    s_cmp_lg_u32 s96, 0
    s_cbranch_scc1 Lw_65
    s_waitcnt vmcnt(6)
Lw_65:
    buffer_load_dwordx4 v6, s[48:51], s41 offen offset:0 nt lds
    buffer_load_dwordx4 v7, s[48:51], s41 offen offset:1024 nt lds
    s_waitcnt vmcnt(8)
    s_cmp_lg_u32 s96, 0
    s_cbranch_scc1 Lw_66
    s_waitcnt vmcnt(6)
Lw_66:
    buffer_load_dwordx4 v6, s[48:51], s41 offen offset:2048 nt lds
    buffer_load_dwordx4 v7, s[48:51], s41 offen offset:3072 nt lds
    v_mfma_f32_16x16x32_bf16 v[68:71], v[144:147], v[48:51], 0
    v_mfma_f32_16x16x32_bf16 v[68:71], v[148:151], v[52:55], v[68:71]
    v_mfma_f32_16x16x32_bf16 v[68:71], v[152:155], v[56:59], v[68:71]
    v_mfma_f32_16x16x32_bf16 v[68:71], v[156:159], v[60:63], v[68:71]
    ds_read_b128 v[144:147], v16 offset:28672
    ds_read_b128 v[148:151], v17 offset:28672
    ds_read_b128 v[152:155], v18 offset:28672
    ds_read_b128 v[156:159], v19 offset:28672
    s_waitcnt lgkmcnt(0)
    s_add_u32 s41, s62, 16384
    s_add_u32 m0, s32, 28672
    s_waitcnt vmcnt(8)
    s_cmp_lg_u32 s96, 0
    s_cbranch_scc1 Lw_67
    s_waitcnt vmcnt(6)
Lw_67:
    buffer_load_dwordx4 v6, s[48:51], s41 offen offset:0 nt lds
    buffer_load_dwordx4 v7, s[48:51], s41 offen offset:1024 nt lds
    s_waitcnt vmcnt(8)
    s_cmp_lg_u32 s96, 0
    s_cbranch_scc1 Lw_68
    s_waitcnt vmcnt(6)
Lw_68:
    buffer_load_dwordx4 v6, s[48:51], s41 offen offset:2048 nt lds
    buffer_load_dwordx4 v7, s[48:51], s41 offen offset:3072 nt lds
    v_mfma_f32_16x16x32_bf16 v[72:75], v[160:163], v[48:51], 0
    v_mfma_f32_16x16x32_bf16 v[72:75], v[164:167], v[52:55], v[72:75]
    v_mfma_f32_16x16x32_bf16 v[72:75], v[168:171], v[56:59], v[72:75]
    v_mfma_f32_16x16x32_bf16 v[72:75], v[172:175], v[60:63], v[72:75]
    ds_read_b128 v[160:163], v16 offset:0
    ds_read_b128 v[164:167], v17 offset:0
    ds_read_b128 v[168:171], v18 offset:0
    ds_read_b128 v[172:175], v19 offset:0
    v_mfma_f32_16x16x32_bf16 v[76:79], v[176:179], v[48:51], 0
    v_mfma_f32_16x16x32_bf16 v[76:79], v[180:183], v[52:55], v[76:79]
    v_mfma_f32_16x16x32_bf16 v[76:79], v[184:187], v[56:59], v[76:79]
    v_mfma_f32_16x16x32_bf16 v[76:79], v[188:191], v[60:63], v[76:79]
    ds_read_b128 v[176:179], v16 offset:4096
    ds_read_b128 v[180:183], v17 offset:4096
    ds_read_b128 v[184:187], v18 offset:4096
    ds_read_b128 v[188:191], v19 offset:4096
    v_mfma_f32_16x16x32_bf16 v[80:83], v[192:195], v[48:51], 0
    v_mfma_f32_16x16x32_bf16 v[80:83], v[196:199], v[52:55], v[80:83]
    v_mfma_f32_16x16x32_bf16 v[80:83], v[200:203], v[56:59], v[80:83]
    v_mfma_f32_16x16x32_bf16 v[80:83], v[204:207], v[60:63], v[80:83]
    ds_read_b128 v[192:195], v16 offset:8192
    ds_read_b128 v[196:199], v17 offset:8192
    ds_read_b128 v[200:203], v18 offset:8192
    ds_read_b128 v[204:207], v19 offset:8192
    v_mfma_f32_16x16x32_bf16 v[84:87], v[208:211], v[48:51], 0
    v_mfma_f32_16x16x32_bf16 v[84:87], v[212:215], v[52:55], v[84:87]
    v_mfma_f32_16x16x32_bf16 v[84:87], v[216:219], v[56:59], v[84:87]
    v_mfma_f32_16x16x32_bf16 v[84:87], v[220:223], v[60:63], v[84:87]
    ds_read_b128 v[208:211], v16 offset:12288
    ds_read_b128 v[212:215], v17 offset:12288
    ds_read_b128 v[216:219], v18 offset:12288
    ds_read_b128 v[220:223], v19 offset:12288
    v_mfma_f32_16x16x32_bf16 v[88:91], v[224:227], v[48:51], 0
    v_mfma_f32_16x16x32_bf16 v[88:91], v[228:231], v[52:55], v[88:91]
    v_mfma_f32_16x16x32_bf16 v[88:91], v[232:235], v[56:59], v[88:91]
    v_mfma_f32_16x16x32_bf16 v[88:91], v[236:239], v[60:63], v[88:91]
    ds_read_b128 v[224:227], v16 offset:16384
    ds_read_b128 v[228:231], v17 offset:16384
    ds_read_b128 v[232:235], v18 offset:16384
    ds_read_b128 v[236:239], v19 offset:16384
    v_mfma_f32_16x16x32_bf16 v[92:95], v[240:243], v[48:51], 0
    v_mfma_f32_16x16x32_bf16 v[92:95], v[244:247], v[52:55], v[92:95]
    v_mfma_f32_16x16x32_bf16 v[92:95], v[248:251], v[56:59], v[92:95]
    v_mfma_f32_16x16x32_bf16 v[92:95], v[252:255], v[60:63], v[92:95]
    s_waitcnt vmcnt(8)
    ds_read_b128 v[240:243], v16 offset:20480
    ds_read_b128 v[244:247], v17 offset:20480
    ds_read_b128 v[248:251], v18 offset:20480
    ds_read_b128 v[252:255], v19 offset:20480
    s_waitcnt lgkmcnt(0)
    v_mfma_f32_16x16x32_bf16 v[96:99], v[128:131], v[48:51], 0
    v_mfma_f32_16x16x32_bf16 v[96:99], v[132:135], v[52:55], v[96:99]
    v_mfma_f32_16x16x32_bf16 v[96:99], v[136:139], v[56:59], v[96:99]
    v_mfma_f32_16x16x32_bf16 v[96:99], v[140:143], v[60:63], v[96:99]
    v_mfma_f32_16x16x32_bf16 v[100:103], v[144:147], v[48:51], 0
    v_mfma_f32_16x16x32_bf16 v[100:103], v[148:151], v[52:55], v[100:103]
    v_mfma_f32_16x16x32_bf16 v[100:103], v[152:155], v[56:59], v[100:103]
    v_mfma_f32_16x16x32_bf16 v[100:103], v[156:159], v[60:63], v[100:103]
    v_mfma_f32_16x16x32_bf16 v[104:107], v[160:163], v[48:51], 0
    v_mfma_f32_16x16x32_bf16 v[104:107], v[164:167], v[52:55], v[104:107]
    v_mfma_f32_16x16x32_bf16 v[104:107], v[168:171], v[56:59], v[104:107]
    v_mfma_f32_16x16x32_bf16 v[104:107], v[172:175], v[60:63], v[104:107]
    v_mfma_f32_16x16x32_bf16 v[108:111], v[176:179], v[48:51], 0
    v_mfma_f32_16x16x32_bf16 v[108:111], v[180:183], v[52:55], v[108:111]
    v_mfma_f32_16x16x32_bf16 v[108:111], v[184:187], v[56:59], v[108:111]
    v_mfma_f32_16x16x32_bf16 v[108:111], v[188:191], v[60:63], v[108:111]
    v_mfma_f32_16x16x32_bf16 v[112:115], v[192:195], v[48:51], 0
    v_mfma_f32_16x16x32_bf16 v[112:115], v[196:199], v[52:55], v[112:115]
    v_mfma_f32_16x16x32_bf16 v[112:115], v[200:203], v[56:59], v[112:115]
    v_mfma_f32_16x16x32_bf16 v[112:115], v[204:207], v[60:63], v[112:115]
    v_mfma_f32_16x16x32_bf16 v[116:119], v[208:211], v[48:51], 0
    v_mfma_f32_16x16x32_bf16 v[116:119], v[212:215], v[52:55], v[116:119]
    v_mfma_f32_16x16x32_bf16 v[116:119], v[216:219], v[56:59], v[116:119]
    v_mfma_f32_16x16x32_bf16 v[116:119], v[220:223], v[60:63], v[116:119]
    v_mfma_f32_16x16x32_bf16 v[120:123], v[224:227], v[48:51], 0
    v_mfma_f32_16x16x32_bf16 v[120:123], v[228:231], v[52:55], v[120:123]
    v_mfma_f32_16x16x32_bf16 v[120:123], v[232:235], v[56:59], v[120:123]
    v_mfma_f32_16x16x32_bf16 v[120:123], v[236:239], v[60:63], v[120:123]
    v_mfma_f32_16x16x32_bf16 v[124:127], v[240:243], v[48:51], 0
    v_mfma_f32_16x16x32_bf16 v[124:127], v[244:247], v[52:55], v[124:127]
    v_mfma_f32_16x16x32_bf16 v[124:127], v[248:251], v[56:59], v[124:127]
    v_mfma_f32_16x16x32_bf16 v[124:127], v[252:255], v[60:63], v[124:127]
    s_add_u32 s41, s62, 32768
    s_add_u32 m0, s32, 0
    s_cmp_lg_u32 s96, 0
    s_nop 3
    s_cbranch_scc1 Lw_69
    s_waitcnt vmcnt(6)
Lw_69:
    buffer_load_dwordx4 v6, s[48:51], s41 offen offset:0 nt lds
    buffer_load_dwordx4 v7, s[48:51], s41 offen offset:1024 nt lds
    s_waitcnt vmcnt(8)
    s_cmp_lg_u32 s96, 0
    s_cbranch_scc1 Lw_70
    s_waitcnt vmcnt(6)
Lw_70:
    buffer_load_dwordx4 v6, s[48:51], s41 offen offset:2048 nt lds
    buffer_load_dwordx4 v7, s[48:51], s41 offen offset:3072 nt lds
    v_cvt_pk_bf16_f32 v30, v64, v65
    v_lshlrev_b32 v64, 16, v30
    v_and_b32 v65, 0xffff0000, v30
    v_mul_f32 v64, s42, v64
    v_mul_f32 v65, s42, v65
    v_cvt_pk_bf16_f32 v30, v64, v65
    v_lshlrev_b32 v64, 16, v30
    v_and_b32 v65, 0xffff0000, v30
    v_max_f32 v28, v64, v65
    v_cvt_pk_bf16_f32 v31, v66, v67
    v_lshlrev_b32 v66, 16, v31
    v_and_b32 v67, 0xffff0000, v31
    v_mul_f32 v66, s42, v66
    v_mul_f32 v67, s42, v67
    v_cvt_pk_bf16_f32 v31, v66, v67
    v_lshlrev_b32 v66, 16, v31
    v_and_b32 v67, 0xffff0000, v31
    v_max3_f32 v28, v28, v66, v67
    v_cvt_pk_bf16_f32 v30, v68, v69
    v_lshlrev_b32 v68, 16, v30
    v_and_b32 v69, 0xffff0000, v30
    v_mul_f32 v68, s42, v68
    v_mul_f32 v69, s42, v69
    v_cvt_pk_bf16_f32 v30, v68, v69
    v_lshlrev_b32 v68, 16, v30
    v_and_b32 v69, 0xffff0000, v30
    v_max3_f32 v28, v28, v68, v69
    v_cvt_pk_bf16_f32 v31, v70, v71
    v_lshlrev_b32 v70, 16, v31
    v_and_b32 v71, 0xffff0000, v31
    v_mul_f32 v70, s42, v70
    v_mul_f32 v71, s42, v71
    v_cvt_pk_bf16_f32 v31, v70, v71
    v_lshlrev_b32 v70, 16, v31
    v_and_b32 v71, 0xffff0000, v31
    v_max3_f32 v28, v28, v70, v71
    v_cvt_pk_bf16_f32 v30, v72, v73
    v_lshlrev_b32 v72, 16, v30
    v_and_b32 v73, 0xffff0000, v30
    v_mul_f32 v72, s42, v72
    v_mul_f32 v73, s42, v73
    v_cvt_pk_bf16_f32 v30, v72, v73
    v_lshlrev_b32 v72, 16, v30
    v_and_b32 v73, 0xffff0000, v30
    v_max3_f32 v28, v28, v72, v73
    v_cvt_pk_bf16_f32 v31, v74, v75
    v_lshlrev_b32 v74, 16, v31
    v_and_b32 v75, 0xffff0000, v31
    v_mul_f32 v74, s42, v74
    v_mul_f32 v75, s42, v75
    v_cvt_pk_bf16_f32 v31, v74, v75
    v_lshlrev_b32 v74, 16, v31
    v_and_b32 v75, 0xffff0000, v31
    v_max3_f32 v28, v28, v74, v75
    v_cvt_pk_bf16_f32 v30, v76, v77
    v_lshlrev_b32 v76, 16, v30
    v_and_b32 v77, 0xffff0000, v30
    v_mul_f32 v76, s42, v76
    v_mul_f32 v77, s42, v77
    v_cvt_pk_bf16_f32 v30, v76, v77
    v_lshlrev_b32 v76, 16, v30
    v_and_b32 v77, 0xffff0000, v30
    v_max3_f32 v28, v28, v76, v77
    v_cvt_pk_bf16_f32 v31, v78, v79
    v_lshlrev_b32 v78, 16, v31
    v_and_b32 v79, 0xffff0000, v31
    v_mul_f32 v78, s42, v78
    v_mul_f32 v79, s42, v79
    v_cvt_pk_bf16_f32 v31, v78, v79
    v_lshlrev_b32 v78, 16, v31
    v_and_b32 v79, 0xffff0000, v31
    v_max3_f32 v28, v28, v78, v79
    v_cvt_pk_bf16_f32 v30, v80, v81
    v_lshlrev_b32 v80, 16, v30
    v_and_b32 v81, 0xffff0000, v30
    v_mul_f32 v80, s42, v80
    v_mul_f32 v81, s42, v81
    v_cvt_pk_bf16_f32 v30, v80, v81
    v_lshlrev_b32 v80, 16, v30
    v_and_b32 v81, 0xffff0000, v30
    v_max3_f32 v28, v28, v80, v81
    v_cvt_pk_bf16_f32 v31, v82, v83
    v_lshlrev_b32 v82, 16, v31
    v_and_b32 v83, 0xffff0000, v31
    v_mul_f32 v82, s42, v82
    v_mul_f32 v83, s42, v83
    v_cvt_pk_bf16_f32 v31, v82, v83
    v_lshlrev_b32 v82, 16, v31
    v_and_b32 v83, 0xffff0000, v31
    v_max3_f32 v28, v28, v82, v83
    v_cvt_pk_bf16_f32 v30, v84, v85
    v_lshlrev_b32 v84, 16, v30
    v_and_b32 v85, 0xffff0000, v30
    v_mul_f32 v84, s42, v84
    v_mul_f32 v85, s42, v85
    v_cvt_pk_bf16_f32 v30, v84, v85
    v_lshlrev_b32 v84, 16, v30
    v_and_b32 v85, 0xffff0000, v30
    v_max3_f32 v28, v28, v84, v85
    v_cvt_pk_bf16_f32 v31, v86, v87
    v_lshlrev_b32 v86, 16, v31
    v_and_b32 v87, 0xffff0000, v31
    v_mul_f32 v86, s42, v86
    v_mul_f32 v87, s42, v87
    v_cvt_pk_bf16_f32 v31, v86, v87
    v_lshlrev_b32 v86, 16, v31
    v_and_b32 v87, 0xffff0000, v31
    v_max3_f32 v28, v28, v86, v87
    s_add_u32 s41, s62, 49152
    s_add_u32 m0, s32, 4096
    s_waitcnt vmcnt(8)
    s_cmp_lg_u32 s96, 0
    s_cbranch_scc1 Lw_71
    s_waitcnt vmcnt(6)
Lw_71:
    buffer_load_dwordx4 v6, s[48:51], s41 offen offset:0 nt lds
    buffer_load_dwordx4 v7, s[48:51], s41 offen offset:1024 nt lds
    s_waitcnt vmcnt(8)
    s_cmp_lg_u32 s96, 0
    s_cbranch_scc1 Lw_72
    s_waitcnt vmcnt(6)
Lw_72:
    buffer_load_dwordx4 v6, s[48:51], s41 offen offset:2048 nt lds
    buffer_load_dwordx4 v7, s[48:51], s41 offen offset:3072 nt lds
    v_cvt_pk_bf16_f32 v30, v88, v89
    v_lshlrev_b32 v88, 16, v30
    v_and_b32 v89, 0xffff0000, v30
    v_mul_f32 v88, s42, v88
    v_mul_f32 v89, s42, v89
    v_cvt_pk_bf16_f32 v30, v88, v89
    v_lshlrev_b32 v88, 16, v30
    v_and_b32 v89, 0xffff0000, v30
    v_max3_f32 v28, v28, v88, v89
    v_cvt_pk_bf16_f32 v31, v90, v91
    v_lshlrev_b32 v90, 16, v31
    v_and_b32 v91, 0xffff0000, v31
    v_mul_f32 v90, s42, v90
    v_mul_f32 v91, s42, v91
    v_cvt_pk_bf16_f32 v31, v90, v91
    v_lshlrev_b32 v90, 16, v31
    v_and_b32 v91, 0xffff0000, v31
    v_max3_f32 v28, v28, v90, v91
    v_cvt_pk_bf16_f32 v30, v92, v93
    v_lshlrev_b32 v92, 16, v30
    v_and_b32 v93, 0xffff0000, v30
    v_mul_f32 v92, s42, v92
    v_mul_f32 v93, s42, v93
    v_cvt_pk_bf16_f32 v30, v92, v93
    v_lshlrev_b32 v92, 16, v30
    v_and_b32 v93, 0xffff0000, v30
    v_max3_f32 v28, v28, v92, v93
    v_cvt_pk_bf16_f32 v31, v94, v95
    v_lshlrev_b32 v94, 16, v31
    v_and_b32 v95, 0xffff0000, v31
    v_mul_f32 v94, s42, v94
    v_mul_f32 v95, s42, v95
    v_cvt_pk_bf16_f32 v31, v94, v95
    v_lshlrev_b32 v94, 16, v31
    v_and_b32 v95, 0xffff0000, v31
    v_max3_f32 v28, v28, v94, v95
    v_cvt_pk_bf16_f32 v30, v96, v97
    v_lshlrev_b32 v96, 16, v30
    v_and_b32 v97, 0xffff0000, v30
    v_mul_f32 v96, s42, v96
    v_mul_f32 v97, s42, v97
    v_cvt_pk_bf16_f32 v30, v96, v97
    v_lshlrev_b32 v96, 16, v30
    v_and_b32 v97, 0xffff0000, v30
    v_max3_f32 v28, v28, v96, v97
    v_cvt_pk_bf16_f32 v31, v98, v99
    v_lshlrev_b32 v98, 16, v31
    v_and_b32 v99, 0xffff0000, v31
    v_mul_f32 v98, s42, v98
    v_mul_f32 v99, s42, v99
    v_cvt_pk_bf16_f32 v31, v98, v99
    v_lshlrev_b32 v98, 16, v31
    v_and_b32 v99, 0xffff0000, v31
    v_max3_f32 v28, v28, v98, v99
    v_cvt_pk_bf16_f32 v30, v100, v101
    v_lshlrev_b32 v100, 16, v30
    v_and_b32 v101, 0xffff0000, v30
    v_mul_f32 v100, s42, v100
    v_mul_f32 v101, s42, v101
    v_cvt_pk_bf16_f32 v30, v100, v101
    v_lshlrev_b32 v100, 16, v30
    v_and_b32 v101, 0xffff0000, v30
    v_max3_f32 v28, v28, v100, v101
    v_cvt_pk_bf16_f32 v31, v102, v103
    v_lshlrev_b32 v102, 16, v31
    v_and_b32 v103, 0xffff0000, v31
    v_mul_f32 v102, s42, v102
    v_mul_f32 v103, s42, v103
    v_cvt_pk_bf16_f32 v31, v102, v103
    v_lshlrev_b32 v102, 16, v31
    v_and_b32 v103, 0xffff0000, v31
    v_max3_f32 v28, v28, v102, v103
    v_cvt_pk_bf16_f32 v30, v104, v105
    v_lshlrev_b32 v104, 16, v30
    v_and_b32 v105, 0xffff0000, v30
    v_mul_f32 v104, s42, v104
    v_mul_f32 v105, s42, v105
    v_cvt_pk_bf16_f32 v30, v104, v105
    v_lshlrev_b32 v104, 16, v30
    v_and_b32 v105, 0xffff0000, v30
    v_max3_f32 v28, v28, v104, v105
    v_cvt_pk_bf16_f32 v31, v106, v107
    v_lshlrev_b32 v106, 16, v31
    v_and_b32 v107, 0xffff0000, v31
    v_mul_f32 v106, s42, v106
    v_mul_f32 v107, s42, v107
    v_cvt_pk_bf16_f32 v31, v106, v107
    v_lshlrev_b32 v106, 16, v31
    v_and_b32 v107, 0xffff0000, v31
    v_max3_f32 v28, v28, v106, v107
    s_add_u32 s41, s62, 65536
    s_add_u32 m0, s32, 8192
    s_waitcnt vmcnt(8)
    s_cmp_lg_u32 s96, 0
    s_cbranch_scc1 Lw_73
    s_waitcnt vmcnt(6)
Lw_73:
    buffer_load_dwordx4 v6, s[48:51], s41 offen offset:0 nt lds
    buffer_load_dwordx4 v7, s[48:51], s41 offen offset:1024 nt lds
    s_waitcnt vmcnt(8)
    s_cmp_lg_u32 s96, 0
    s_cbranch_scc1 Lw_74
    s_waitcnt vmcnt(6)
Lw_74:
    buffer_load_dwordx4 v6, s[48:51], s41 offen offset:2048 nt lds
    buffer_load_dwordx4 v7, s[48:51], s41 offen offset:3072 nt lds
    v_cvt_pk_bf16_f32 v30, v108, v109
    v_lshlrev_b32 v108, 16, v30
    v_and_b32 v109, 0xffff0000, v30
    v_mul_f32 v108, s42, v108
    v_mul_f32 v109, s42, v109
    v_cvt_pk_bf16_f32 v30, v108, v109
    v_lshlrev_b32 v108, 16, v30
    v_and_b32 v109, 0xffff0000, v30
    v_max3_f32 v28, v28, v108, v109
    v_cvt_pk_bf16_f32 v31, v110, v111
    v_lshlrev_b32 v110, 16, v31
    v_and_b32 v111, 0xffff0000, v31
    v_mul_f32 v110, s42, v110
    v_mul_f32 v111, s42, v111
    v_cvt_pk_bf16_f32 v31, v110, v111
    v_lshlrev_b32 v110, 16, v31
    v_and_b32 v111, 0xffff0000, v31
    v_max3_f32 v28, v28, v110, v111
    v_cvt_pk_bf16_f32 v30, v112, v113
    v_lshlrev_b32 v112, 16, v30
    v_and_b32 v113, 0xffff0000, v30
    v_mul_f32 v112, s42, v112
    v_mul_f32 v113, s42, v113
    v_cvt_pk_bf16_f32 v30, v112, v113
    v_lshlrev_b32 v112, 16, v30
    v_and_b32 v113, 0xffff0000, v30
    v_max3_f32 v28, v28, v112, v113
    v_cvt_pk_bf16_f32 v31, v114, v115
    v_lshlrev_b32 v114, 16, v31
    v_and_b32 v115, 0xffff0000, v31
    v_mul_f32 v114, s42, v114
    v_mul_f32 v115, s42, v115
    v_cvt_pk_bf16_f32 v31, v114, v115
    v_lshlrev_b32 v114, 16, v31
    v_and_b32 v115, 0xffff0000, v31
    v_max3_f32 v28, v28, v114, v115
    v_cvt_pk_bf16_f32 v30, v116, v117
    v_lshlrev_b32 v116, 16, v30
    v_and_b32 v117, 0xffff0000, v30
    v_mul_f32 v116, s42, v116
    v_mul_f32 v117, s42, v117
    v_cvt_pk_bf16_f32 v30, v116, v117
    v_lshlrev_b32 v116, 16, v30
    v_and_b32 v117, 0xffff0000, v30
    v_max3_f32 v28, v28, v116, v117
    v_cvt_pk_bf16_f32 v31, v118, v119
    v_lshlrev_b32 v118, 16, v31
    v_and_b32 v119, 0xffff0000, v31
    v_mul_f32 v118, s42, v118
    v_mul_f32 v119, s42, v119
    v_cvt_pk_bf16_f32 v31, v118, v119
    v_lshlrev_b32 v118, 16, v31
    v_and_b32 v119, 0xffff0000, v31
    v_max3_f32 v28, v28, v118, v119
    v_cvt_pk_bf16_f32 v30, v120, v121
    v_lshlrev_b32 v120, 16, v30
    v_and_b32 v121, 0xffff0000, v30
    v_mul_f32 v120, s42, v120
    v_mul_f32 v121, s42, v121
    v_cvt_pk_bf16_f32 v30, v120, v121
    v_lshlrev_b32 v120, 16, v30
    v_and_b32 v121, 0xffff0000, v30
    v_max3_f32 v28, v28, v120, v121
    v_cvt_pk_bf16_f32 v31, v122, v123
    v_lshlrev_b32 v122, 16, v31
    v_and_b32 v123, 0xffff0000, v31
    v_mul_f32 v122, s42, v122
    v_mul_f32 v123, s42, v123
    v_cvt_pk_bf16_f32 v31, v122, v123
    v_lshlrev_b32 v122, 16, v31
    v_and_b32 v123, 0xffff0000, v31
    v_max3_f32 v28, v28, v122, v123
    v_cvt_pk_bf16_f32 v30, v124, v125
    v_lshlrev_b32 v124, 16, v30
    v_and_b32 v125, 0xffff0000, v30
    v_mul_f32 v124, s42, v124
    v_mul_f32 v125, s42, v125
    v_cvt_pk_bf16_f32 v30, v124, v125
    v_lshlrev_b32 v124, 16, v30
    v_and_b32 v125, 0xffff0000, v30
    v_max3_f32 v28, v28, v124, v125
    v_cvt_pk_bf16_f32 v31, v126, v127
    v_lshlrev_b32 v126, 16, v31
    v_and_b32 v127, 0xffff0000, v31
    v_mul_f32 v126, s42, v126
    v_mul_f32 v127, s42, v127
    v_cvt_pk_bf16_f32 v31, v126, v127
    v_lshlrev_b32 v126, 16, v31
    v_and_b32 v127, 0xffff0000, v31
    v_max3_f32 v28, v28, v126, v127
    s_add_u32 s41, s62, 81920
    s_add_u32 m0, s32, 12288
    s_waitcnt vmcnt(8)
    s_cmp_lg_u32 s96, 0
    s_cbranch_scc1 Lw_75
    s_waitcnt vmcnt(6)
Lw_75:
    buffer_load_dwordx4 v6, s[48:51], s41 offen offset:0 nt lds
    buffer_load_dwordx4 v7, s[48:51], s41 offen offset:1024 nt lds
    s_waitcnt vmcnt(8)
    s_cmp_lg_u32 s96, 0
    s_cbranch_scc1 Lw_76
    s_waitcnt vmcnt(6)
Lw_76:
    buffer_load_dwordx4 v6, s[48:51], s41 offen offset:2048 nt lds
    buffer_load_dwordx4 v7, s[48:51], s41 offen offset:3072 nt lds
    v_mov_b32 v30, v28
    s_nop 1
    v_permlane32_swap_b32 v30, v28
    v_max_f32 v28, v28, v30
    v_mov_b32 v30, v28
    s_nop 1
    v_permlane16_swap_b32 v30, v28
    v_max_f32 v28, v28, v30
    v_mul_f32 v28, s43, v28
    v_fma_f32 v64, v64, s43, -v28
    v_fma_f32 v65, v65, s43, -v28
    v_fma_f32 v66, v66, s43, -v28
    v_fma_f32 v67, v67, s43, -v28
    v_exp_f32 v64, v64
    v_exp_f32 v65, v65
    v_exp_f32 v66, v66
    v_exp_f32 v67, v67
    v_add_f32 v29, v64, v65
    v_cvt_pk_bf16_f32 v128, v64, v65
    v_add_f32 v29, v29, v66
    v_add_f32 v29, v29, v67
    v_cvt_pk_bf16_f32 v129, v66, v67
    v_fma_f32 v68, v68, s43, -v28
    v_fma_f32 v69, v69, s43, -v28
    v_fma_f32 v70, v70, s43, -v28
    v_fma_f32 v71, v71, s43, -v28
    v_exp_f32 v68, v68
    v_exp_f32 v69, v69
    v_exp_f32 v70, v70
    v_exp_f32 v71, v71
    v_add_f32 v29, v29, v68
    v_add_f32 v29, v29, v69
    v_cvt_pk_bf16_f32 v130, v68, v69
    v_add_f32 v29, v29, v70
    v_add_f32 v29, v29, v71
    v_cvt_pk_bf16_f32 v131, v70, v71
    v_fma_f32 v72, v72, s43, -v28
    v_fma_f32 v73, v73, s43, -v28
    v_fma_f32 v74, v74, s43, -v28
    v_fma_f32 v75, v75, s43, -v28
    v_exp_f32 v72, v72
    v_exp_f32 v73, v73
    v_exp_f32 v74, v74
    v_exp_f32 v75, v75
    v_add_f32 v29, v29, v72
    v_add_f32 v29, v29, v73
    v_cvt_pk_bf16_f32 v132, v72, v73
    v_add_f32 v29, v29, v74
    v_add_f32 v29, v29, v75
    v_cvt_pk_bf16_f32 v133, v74, v75
    v_fma_f32 v76, v76, s43, -v28
    v_fma_f32 v77, v77, s43, -v28
    v_fma_f32 v78, v78, s43, -v28
    v_fma_f32 v79, v79, s43, -v28
    v_exp_f32 v76, v76
    v_exp_f32 v77, v77
    v_exp_f32 v78, v78
    v_exp_f32 v79, v79
    v_add_f32 v29, v29, v76
    v_add_f32 v29, v29, v77
    v_cvt_pk_bf16_f32 v134, v76, v77
    v_add_f32 v29, v29, v78
    v_add_f32 v29, v29, v79
    v_cvt_pk_bf16_f32 v135, v78, v79
    v_fma_f32 v80, v80, s43, -v28
    v_fma_f32 v81, v81, s43, -v28
    v_fma_f32 v82, v82, s43, -v28
    v_fma_f32 v83, v83, s43, -v28
    v_exp_f32 v80, v80
    v_exp_f32 v81, v81
    v_exp_f32 v82, v82
    v_exp_f32 v83, v83
    v_add_f32 v29, v29, v80
    v_add_f32 v29, v29, v81
    v_cvt_pk_bf16_f32 v136, v80, v81
    v_add_f32 v29, v29, v82
    v_add_f32 v29, v29, v83
    v_cvt_pk_bf16_f32 v137, v82, v83
    v_fma_f32 v84, v84, s43, -v28
    v_fma_f32 v85, v85, s43, -v28
    v_fma_f32 v86, v86, s43, -v28
    v_fma_f32 v87, v87, s43, -v28
    v_exp_f32 v84, v84
    v_exp_f32 v85, v85
    v_exp_f32 v86, v86
    v_exp_f32 v87, v87
    v_add_f32 v29, v29, v84
    v_add_f32 v29, v29, v85
    v_cvt_pk_bf16_f32 v138, v84, v85
    v_add_f32 v29, v29, v86
    v_add_f32 v29, v29, v87
    v_cvt_pk_bf16_f32 v139, v86, v87
    v_fma_f32 v88, v88, s43, -v28
    v_fma_f32 v89, v89, s43, -v28
    v_fma_f32 v90, v90, s43, -v28
    v_fma_f32 v91, v91, s43, -v28
    v_exp_f32 v88, v88
    v_exp_f32 v89, v89
    v_exp_f32 v90, v90
    v_exp_f32 v91, v91
    v_add_f32 v29, v29, v88
    v_add_f32 v29, v29, v89
    v_cvt_pk_bf16_f32 v140, v88, v89
    v_add_f32 v29, v29, v90
    v_add_f32 v29, v29, v91
    v_cvt_pk_bf16_f32 v141, v90, v91
    v_fma_f32 v92, v92, s43, -v28
    v_fma_f32 v93, v93, s43, -v28
    v_fma_f32 v94, v94, s43, -v28
    v_fma_f32 v95, v95, s43, -v28
    v_exp_f32 v92, v92
    v_exp_f32 v93, v93
    v_exp_f32 v94, v94
    v_exp_f32 v95, v95
    v_add_f32 v29, v29, v92
    v_add_f32 v29, v29, v93
    v_cvt_pk_bf16_f32 v142, v92, v93
    v_add_f32 v29, v29, v94
    v_add_f32 v29, v29, v95
    v_cvt_pk_bf16_f32 v143, v94, v95
    s_add_u32 s41, s62, 98304
    s_add_u32 m0, s32, 16384
    s_waitcnt vmcnt(8)
    s_cmp_lg_u32 s96, 0
    s_cbranch_scc1 Lw_77
    s_waitcnt vmcnt(6)
Lw_77:
    buffer_load_dwordx4 v6, s[48:51], s41 offen offset:0 nt lds
    buffer_load_dwordx4 v7, s[48:51], s41 offen offset:1024 nt lds
    s_waitcnt vmcnt(8)
    s_cmp_lg_u32 s96, 0
    s_cbranch_scc1 Lw_78
    s_waitcnt vmcnt(6)
Lw_78:
    buffer_load_dwordx4 v6, s[48:51], s41 offen offset:2048 nt lds
    buffer_load_dwordx4 v7, s[48:51], s41 offen offset:3072 nt lds
    v_fma_f32 v96, v96, s43, -v28
    v_fma_f32 v97, v97, s43, -v28
    v_fma_f32 v98, v98, s43, -v28
    v_fma_f32 v99, v99, s43, -v28
    v_exp_f32 v96, v96
    v_exp_f32 v97, v97
    v_exp_f32 v98, v98
    v_exp_f32 v99, v99
    v_add_f32 v29, v29, v96
    v_add_f32 v29, v29, v97
    v_cvt_pk_bf16_f32 v144, v96, v97
    v_add_f32 v29, v29, v98
    v_add_f32 v29, v29, v99
    v_cvt_pk_bf16_f32 v145, v98, v99
    v_fma_f32 v100, v100, s43, -v28
    v_fma_f32 v101, v101, s43, -v28
    v_fma_f32 v102, v102, s43, -v28
    v_fma_f32 v103, v103, s43, -v28
    v_exp_f32 v100, v100
    v_exp_f32 v101, v101
    v_exp_f32 v102, v102
    v_exp_f32 v103, v103
    v_add_f32 v29, v29, v100
    v_add_f32 v29, v29, v101
    v_cvt_pk_bf16_f32 v146, v100, v101
    v_add_f32 v29, v29, v102
    v_add_f32 v29, v29, v103
    v_cvt_pk_bf16_f32 v147, v102, v103
    v_fma_f32 v104, v104, s43, -v28
    v_fma_f32 v105, v105, s43, -v28
    v_fma_f32 v106, v106, s43, -v28
    v_fma_f32 v107, v107, s43, -v28
    v_exp_f32 v104, v104
    v_exp_f32 v105, v105
    v_exp_f32 v106, v106
    v_exp_f32 v107, v107
    v_add_f32 v29, v29, v104
    v_add_f32 v29, v29, v105
    v_cvt_pk_bf16_f32 v148, v104, v105
    v_add_f32 v29, v29, v106
    v_add_f32 v29, v29, v107
    v_cvt_pk_bf16_f32 v149, v106, v107
    v_fma_f32 v108, v108, s43, -v28
    v_fma_f32 v109, v109, s43, -v28
    v_fma_f32 v110, v110, s43, -v28
    v_fma_f32 v111, v111, s43, -v28
    v_exp_f32 v108, v108
    v_exp_f32 v109, v109
    v_exp_f32 v110, v110
    v_exp_f32 v111, v111
    v_add_f32 v29, v29, v108
    v_add_f32 v29, v29, v109
    v_cvt_pk_bf16_f32 v150, v108, v109
    v_add_f32 v29, v29, v110
    v_add_f32 v29, v29, v111
    v_cvt_pk_bf16_f32 v151, v110, v111
    v_fma_f32 v112, v112, s43, -v28
    v_fma_f32 v113, v113, s43, -v28
    v_fma_f32 v114, v114, s43, -v28
    v_fma_f32 v115, v115, s43, -v28
    v_exp_f32 v112, v112
    v_exp_f32 v113, v113
    v_exp_f32 v114, v114
    v_exp_f32 v115, v115
    v_add_f32 v29, v29, v112
    v_add_f32 v29, v29, v113
    v_cvt_pk_bf16_f32 v152, v112, v113
    v_add_f32 v29, v29, v114
    v_add_f32 v29, v29, v115
    v_cvt_pk_bf16_f32 v153, v114, v115
    v_fma_f32 v116, v116, s43, -v28
    v_fma_f32 v117, v117, s43, -v28
    v_fma_f32 v118, v118, s43, -v28
    v_fma_f32 v119, v119, s43, -v28
    v_exp_f32 v116, v116
    v_exp_f32 v117, v117
    v_exp_f32 v118, v118
    v_exp_f32 v119, v119
    v_add_f32 v29, v29, v116
    v_add_f32 v29, v29, v117
    v_cvt_pk_bf16_f32 v154, v116, v117
    v_add_f32 v29, v29, v118
    v_add_f32 v29, v29, v119
    v_cvt_pk_bf16_f32 v155, v118, v119
    v_fma_f32 v120, v120, s43, -v28
    v_fma_f32 v121, v121, s43, -v28
    v_fma_f32 v122, v122, s43, -v28
    v_fma_f32 v123, v123, s43, -v28
    v_exp_f32 v120, v120
    v_exp_f32 v121, v121
    v_exp_f32 v122, v122
    v_exp_f32 v123, v123
    v_add_f32 v29, v29, v120
    v_add_f32 v29, v29, v121
    v_cvt_pk_bf16_f32 v156, v120, v121
    v_add_f32 v29, v29, v122
    v_add_f32 v29, v29, v123
    v_cvt_pk_bf16_f32 v157, v122, v123
    v_fma_f32 v124, v124, s43, -v28
    v_fma_f32 v125, v125, s43, -v28
    v_fma_f32 v126, v126, s43, -v28
    v_fma_f32 v127, v127, s43, -v28
    v_exp_f32 v124, v124
    v_exp_f32 v125, v125
    v_exp_f32 v126, v126
    v_exp_f32 v127, v127
    v_add_f32 v29, v29, v124
    v_add_f32 v29, v29, v125
    v_cvt_pk_bf16_f32 v158, v124, v125
    v_add_f32 v29, v29, v126
    v_add_f32 v29, v29, v127
    v_cvt_pk_bf16_f32 v159, v126, v127
    v_mov_b32 v30, v29
    s_nop 1
    v_permlane32_swap_b32 v30, v29
    v_add_f32 v29, v29, v30
    v_mov_b32 v30, v29
    s_nop 1
    v_permlane16_swap_b32 v30, v29
    v_add_f32 v29, v29, v30
    s_lshl_b32 s40, s3, 6
    s_add_u32 s40, s40, 149760
    v_lshl_add_u32 v30, v1, 3, s40
    s_mov_b64 exec, 0xff
    ds_write_b64 v30, v[28:29]
    s_waitcnt lgkmcnt(0)
    s_mov_b64 exec, -1
    s_mov_b64 exec, 1
    ds_add_u32 v13, v14 offset:68
    s_mov_b64 exec, -1
    s_add_u32 s41, s62, 114688
    s_add_u32 m0, s32, 20480
    s_waitcnt vmcnt(8)
    s_cmp_lg_u32 s96, 0
    s_cbranch_scc1 Lw_79
    s_waitcnt vmcnt(6)
Lw_79:
    buffer_load_dwordx4 v6, s[48:51], s41 offen offset:0 nt lds
    buffer_load_dwordx4 v7, s[48:51], s41 offen offset:1024 nt lds
    s_waitcnt vmcnt(8)
    s_cmp_lg_u32 s96, 0
    s_cbranch_scc1 Lw_80
    s_waitcnt vmcnt(6)
Lw_80:
    buffer_load_dwordx4 v6, s[48:51], s41 offen offset:2048 nt lds
    buffer_load_dwordx4 v7, s[48:51], s41 offen offset:3072 nt lds
    ds_read_b64_tr_b16 v[192:193], v20 offset:24576
    ds_read_b64_tr_b16 v[194:195], v20 offset:28672
    ds_read_b64_tr_b16 v[196:197], v21 offset:24576
    ds_read_b64_tr_b16 v[198:199], v21 offset:28672
    ds_read_b64_tr_b16 v[200:201], v22 offset:24576
    ds_read_b64_tr_b16 v[202:203], v22 offset:28672
    ds_read_b64_tr_b16 v[204:205], v23 offset:24576
    ds_read_b64_tr_b16 v[206:207], v23 offset:28672
    ds_read_b64_tr_b16 v[208:209], v24 offset:24576
    ds_read_b64_tr_b16 v[210:211], v24 offset:28672
    ds_read_b64_tr_b16 v[212:213], v25 offset:24576
    ds_read_b64_tr_b16 v[214:215], v25 offset:28672
    ds_read_b64_tr_b16 v[216:217], v26 offset:24576
    ds_read_b64_tr_b16 v[218:219], v26 offset:28672
    ds_read_b64_tr_b16 v[220:221], v27 offset:24576
    ds_read_b64_tr_b16 v[222:223], v27 offset:28672
    s_waitcnt lgkmcnt(14)
    v_mfma_f32_16x16x32_bf16 v[160:163], v[192:195], v[128:131], 0
    s_waitcnt lgkmcnt(12)
    v_mfma_f32_16x16x32_bf16 v[164:167], v[196:199], v[128:131], 0
    s_waitcnt lgkmcnt(10)
    v_mfma_f32_16x16x32_bf16 v[168:171], v[200:203], v[128:131], 0
    s_waitcnt lgkmcnt(8)
    v_mfma_f32_16x16x32_bf16 v[172:175], v[204:207], v[128:131], 0
    s_waitcnt lgkmcnt(6)
    v_mfma_f32_16x16x32_bf16 v[176:179], v[208:211], v[128:131], 0
    s_waitcnt lgkmcnt(4)
    v_mfma_f32_16x16x32_bf16 v[180:183], v[212:215], v[128:131], 0
    s_waitcnt lgkmcnt(2)
    v_mfma_f32_16x16x32_bf16 v[184:187], v[216:219], v[128:131], 0
    s_waitcnt lgkmcnt(0)
    v_mfma_f32_16x16x32_bf16 v[188:191], v[220:223], v[128:131], 0
    s_add_u32 s41, s62, 131072
    s_add_u32 m0, s32, 24576
    s_waitcnt vmcnt(8)
    s_cmp_lg_u32 s96, 0
    s_nop 2
    s_cbranch_scc1 Lw_81
    s_waitcnt vmcnt(6)
Lw_81:
    buffer_load_dwordx4 v6, s[48:51], s41 offen offset:0 nt lds
    buffer_load_dwordx4 v7, s[48:51], s41 offen offset:1024 nt lds
    s_waitcnt vmcnt(8)
    s_cmp_lg_u32 s96, 0
    s_cbranch_scc1 Lw_82
    s_waitcnt vmcnt(6)
Lw_82:
    buffer_load_dwordx4 v6, s[48:51], s41 offen offset:2048 nt lds
    buffer_load_dwordx4 v7, s[48:51], s41 offen offset:3072 nt lds
    s_add_u32 s41, s62, 147456
    s_add_u32 m0, s32, 28672
    s_waitcnt vmcnt(8)
    s_cmp_lg_u32 s96, 0
    s_cbranch_scc1 Lw_83
    s_waitcnt vmcnt(6)
Lw_83:
    buffer_load_dwordx4 v6, s[48:51], s41 offen offset:0 nt lds
    buffer_load_dwordx4 v7, s[48:51], s41 offen offset:1024 nt lds
    s_waitcnt vmcnt(8)
    s_cmp_lg_u32 s96, 0
    s_cbranch_scc1 Lw_84
    s_waitcnt vmcnt(6)
Lw_84:
    buffer_load_dwordx4 v6, s[48:51], s41 offen offset:2048 nt lds
    buffer_load_dwordx4 v7, s[48:51], s41 offen offset:3072 nt lds
    ds_read_b64_tr_b16 v[192:193], v20 offset:0
    ds_read_b64_tr_b16 v[194:195], v20 offset:4096
    ds_read_b64_tr_b16 v[196:197], v21 offset:0
    ds_read_b64_tr_b16 v[198:199], v21 offset:4096
    ds_read_b64_tr_b16 v[200:201], v22 offset:0
    ds_read_b64_tr_b16 v[202:203], v22 offset:4096
    ds_read_b64_tr_b16 v[204:205], v23 offset:0
    ds_read_b64_tr_b16 v[206:207], v23 offset:4096
    ds_read_b64_tr_b16 v[208:209], v24 offset:0
    ds_read_b64_tr_b16 v[210:211], v24 offset:4096
    ds_read_b64_tr_b16 v[212:213], v25 offset:0
    ds_read_b64_tr_b16 v[214:215], v25 offset:4096
    ds_read_b64_tr_b16 v[216:217], v26 offset:0
    ds_read_b64_tr_b16 v[218:219], v26 offset:4096
    ds_read_b64_tr_b16 v[220:221], v27 offset:0
    ds_read_b64_tr_b16 v[222:223], v27 offset:4096
    s_waitcnt lgkmcnt(14)
    v_mfma_f32_16x16x32_bf16 v[160:163], v[192:195], v[132:135], v[160:163]
    s_waitcnt lgkmcnt(12)
    v_mfma_f32_16x16x32_bf16 v[164:167], v[196:199], v[132:135], v[164:167]
    s_waitcnt lgkmcnt(10)
    v_mfma_f32_16x16x32_bf16 v[168:171], v[200:203], v[132:135], v[168:171]
    s_waitcnt lgkmcnt(8)
    v_mfma_f32_16x16x32_bf16 v[172:175], v[204:207], v[132:135], v[172:175]
    s_waitcnt lgkmcnt(6)
    v_mfma_f32_16x16x32_bf16 v[176:179], v[208:211], v[132:135], v[176:179]
    s_waitcnt lgkmcnt(4)
    v_mfma_f32_16x16x32_bf16 v[180:183], v[212:215], v[132:135], v[180:183]
    s_waitcnt lgkmcnt(2)
    v_mfma_f32_16x16x32_bf16 v[184:187], v[216:219], v[132:135], v[184:187]
    s_waitcnt lgkmcnt(0)
    v_mfma_f32_16x16x32_bf16 v[188:191], v[220:223], v[132:135], v[188:191]
    s_add_u32 s41, s62, 163840
    s_add_u32 m0, s32, 0
    s_waitcnt vmcnt(8)
    s_cmp_lg_u32 s96, 0
    s_nop 2
    s_cbranch_scc1 Lw_85
    s_waitcnt vmcnt(6)
Lw_85:
    buffer_load_dwordx4 v6, s[48:51], s41 offen offset:0 nt lds
    buffer_load_dwordx4 v7, s[48:51], s41 offen offset:1024 nt lds
    s_waitcnt vmcnt(8)
    s_cmp_lg_u32 s96, 0
    s_cbranch_scc1 Lw_86
    s_waitcnt vmcnt(6)
Lw_86:
    buffer_load_dwordx4 v6, s[48:51], s41 offen offset:2048 nt lds
    buffer_load_dwordx4 v7, s[48:51], s41 offen offset:3072 nt lds
    s_add_u32 s41, s62, 180224
    s_add_u32 m0, s32, 4096
    s_waitcnt vmcnt(8)
    s_cmp_lg_u32 s96, 0
    s_cbranch_scc1 Lw_87
    s_waitcnt vmcnt(6)
Lw_87:
    buffer_load_dwordx4 v6, s[48:51], s41 offen offset:0 nt lds
    buffer_load_dwordx4 v7, s[48:51], s41 offen offset:1024 nt lds
    s_waitcnt vmcnt(8)
    s_cmp_lg_u32 s96, 0
    s_cbranch_scc1 Lw_88
    s_waitcnt vmcnt(6)
Lw_88:
    buffer_load_dwordx4 v6, s[48:51], s41 offen offset:2048 nt lds
    buffer_load_dwordx4 v7, s[48:51], s41 offen offset:3072 nt lds
    ds_read_b64_tr_b16 v[192:193], v20 offset:8192
    ds_read_b64_tr_b16 v[194:195], v20 offset:12288
    ds_read_b64_tr_b16 v[196:197], v21 offset:8192
    ds_read_b64_tr_b16 v[198:199], v21 offset:12288
    ds_read_b64_tr_b16 v[200:201], v22 offset:8192
    ds_read_b64_tr_b16 v[202:203], v22 offset:12288
    ds_read_b64_tr_b16 v[204:205], v23 offset:8192
    ds_read_b64_tr_b16 v[206:207], v23 offset:12288
    ds_read_b64_tr_b16 v[208:209], v24 offset:8192
    ds_read_b64_tr_b16 v[210:211], v24 offset:12288
    ds_read_b64_tr_b16 v[212:213], v25 offset:8192
    ds_read_b64_tr_b16 v[214:215], v25 offset:12288
    ds_read_b64_tr_b16 v[216:217], v26 offset:8192
    ds_read_b64_tr_b16 v[218:219], v26 offset:12288
    ds_read_b64_tr_b16 v[220:221], v27 offset:8192
    ds_read_b64_tr_b16 v[222:223], v27 offset:12288
    s_waitcnt lgkmcnt(14)
    v_mfma_f32_16x16x32_bf16 v[160:163], v[192:195], v[136:139], v[160:163]
    s_waitcnt lgkmcnt(12)
    v_mfma_f32_16x16x32_bf16 v[164:167], v[196:199], v[136:139], v[164:167]
    s_waitcnt lgkmcnt(10)
    v_mfma_f32_16x16x32_bf16 v[168:171], v[200:203], v[136:139], v[168:171]
    s_waitcnt lgkmcnt(8)
    v_mfma_f32_16x16x32_bf16 v[172:175], v[204:207], v[136:139], v[172:175]
    s_waitcnt lgkmcnt(6)
    v_mfma_f32_16x16x32_bf16 v[176:179], v[208:211], v[136:139], v[176:179]
    s_waitcnt lgkmcnt(4)
    v_mfma_f32_16x16x32_bf16 v[180:183], v[212:215], v[136:139], v[180:183]
    s_waitcnt lgkmcnt(2)
    v_mfma_f32_16x16x32_bf16 v[184:187], v[216:219], v[136:139], v[184:187]
    s_waitcnt lgkmcnt(0)
    v_mfma_f32_16x16x32_bf16 v[188:191], v[220:223], v[136:139], v[188:191]
    s_add_u32 s41, s62, 196608
    s_add_u32 m0, s32, 8192
    s_waitcnt vmcnt(8)
    s_cmp_lg_u32 s96, 0
    s_nop 2
    s_cbranch_scc1 Lw_89
    s_waitcnt vmcnt(6)
Lw_89:
    buffer_load_dwordx4 v6, s[48:51], s41 offen offset:0 nt lds
    buffer_load_dwordx4 v7, s[48:51], s41 offen offset:1024 nt lds
    s_waitcnt vmcnt(8)
    s_cmp_lg_u32 s96, 0
    s_cbranch_scc1 Lw_90
    s_waitcnt vmcnt(6)
Lw_90:
    buffer_load_dwordx4 v6, s[48:51], s41 offen offset:2048 nt lds
    buffer_load_dwordx4 v7, s[48:51], s41 offen offset:3072 nt lds
    s_add_u32 s41, s62, 212992
    s_add_u32 m0, s32, 12288
    s_waitcnt vmcnt(8)
    s_cmp_lg_u32 s96, 0
    s_cbranch_scc1 Lw_91
    s_waitcnt vmcnt(6)
Lw_91:
    buffer_load_dwordx4 v6, s[48:51], s41 offen offset:0 nt lds
    buffer_load_dwordx4 v7, s[48:51], s41 offen offset:1024 nt lds
    s_waitcnt vmcnt(8)
    s_cmp_lg_u32 s96, 0
    s_cbranch_scc1 Lw_92
    s_waitcnt vmcnt(6)
Lw_92:
    buffer_load_dwordx4 v6, s[48:51], s41 offen offset:2048 nt lds
    buffer_load_dwordx4 v7, s[48:51], s41 offen offset:3072 nt lds
    s_mov_b64 exec, 1
    ds_add_u32 v13, v14 offset:80
    s_mov_b64 exec, -1
    ds_read_b64_tr_b16 v[192:193], v20 offset:16384
    ds_read_b64_tr_b16 v[194:195], v20 offset:20480
    ds_read_b64_tr_b16 v[196:197], v21 offset:16384
    ds_read_b64_tr_b16 v[198:199], v21 offset:20480
    ds_read_b64_tr_b16 v[200:201], v22 offset:16384
    ds_read_b64_tr_b16 v[202:203], v22 offset:20480
    ds_read_b64_tr_b16 v[204:205], v23 offset:16384
    ds_read_b64_tr_b16 v[206:207], v23 offset:20480
    ds_read_b64_tr_b16 v[208:209], v24 offset:16384
    ds_read_b64_tr_b16 v[210:211], v24 offset:20480
    ds_read_b64_tr_b16 v[212:213], v25 offset:16384
    ds_read_b64_tr_b16 v[214:215], v25 offset:20480
    ds_read_b64_tr_b16 v[216:217], v26 offset:16384
    ds_read_b64_tr_b16 v[218:219], v26 offset:20480
    ds_read_b64_tr_b16 v[220:221], v27 offset:16384
    ds_read_b64_tr_b16 v[222:223], v27 offset:20480
    s_waitcnt lgkmcnt(14)
    v_mfma_f32_16x16x32_bf16 v[160:163], v[192:195], v[140:143], v[160:163]
    s_waitcnt lgkmcnt(12)
    v_mfma_f32_16x16x32_bf16 v[164:167], v[196:199], v[140:143], v[164:167]
    s_waitcnt lgkmcnt(10)
    v_mfma_f32_16x16x32_bf16 v[168:171], v[200:203], v[140:143], v[168:171]
    s_waitcnt lgkmcnt(8)
    v_mfma_f32_16x16x32_bf16 v[172:175], v[204:207], v[140:143], v[172:175]
    s_waitcnt lgkmcnt(6)
    v_mfma_f32_16x16x32_bf16 v[176:179], v[208:211], v[140:143], v[176:179]
    s_waitcnt lgkmcnt(4)
    v_mfma_f32_16x16x32_bf16 v[180:183], v[212:215], v[140:143], v[180:183]
    s_waitcnt lgkmcnt(2)
    v_mfma_f32_16x16x32_bf16 v[184:187], v[216:219], v[140:143], v[184:187]
    s_waitcnt lgkmcnt(0)
    v_mfma_f32_16x16x32_bf16 v[188:191], v[220:223], v[140:143], v[188:191]
    s_add_u32 s41, s62, 229376
    s_add_u32 m0, s32, 16384
    s_waitcnt vmcnt(8)
    s_cmp_lg_u32 s96, 0
    s_nop 2
    s_cbranch_scc1 Lw_93
    s_waitcnt vmcnt(6)
Lw_93:
    buffer_load_dwordx4 v6, s[48:51], s41 offen offset:0 nt lds
    buffer_load_dwordx4 v7, s[48:51], s41 offen offset:1024 nt lds
    s_waitcnt vmcnt(8)
    s_cmp_lg_u32 s96, 0
    s_cbranch_scc1 Lw_94
    s_waitcnt vmcnt(6)
Lw_94:
    buffer_load_dwordx4 v6, s[48:51], s41 offen offset:2048 nt lds
    buffer_load_dwordx4 v7, s[48:51], s41 offen offset:3072 nt lds
    s_add_u32 s41, s62, 245760
    s_add_u32 m0, s32, 20480
    s_waitcnt vmcnt(8)
    s_cmp_lg_u32 s96, 0
    s_cbranch_scc1 Lw_95
    s_waitcnt vmcnt(6)
Lw_95:
    buffer_load_dwordx4 v6, s[48:51], s41 offen offset:0 nt lds
    buffer_load_dwordx4 v7, s[48:51], s41 offen offset:1024 nt lds
    s_waitcnt vmcnt(8)
    s_cmp_lg_u32 s96, 0
    s_cbranch_scc1 Lw_96
    s_waitcnt vmcnt(6)
Lw_96:
    buffer_load_dwordx4 v6, s[48:51], s41 offen offset:2048 nt lds
    buffer_load_dwordx4 v7, s[48:51], s41 offen offset:3072 nt lds
    ds_read_b64_tr_b16 v[192:193], v20 offset:24576
    ds_read_b64_tr_b16 v[194:195], v20 offset:28672
    ds_read_b64_tr_b16 v[196:197], v21 offset:24576
    ds_read_b64_tr_b16 v[198:199], v21 offset:28672
    ds_read_b64_tr_b16 v[200:201], v22 offset:24576
    ds_read_b64_tr_b16 v[202:203], v22 offset:28672
    ds_read_b64_tr_b16 v[204:205], v23 offset:24576
    ds_read_b64_tr_b16 v[206:207], v23 offset:28672
    ds_read_b64_tr_b16 v[208:209], v24 offset:24576
    ds_read_b64_tr_b16 v[210:211], v24 offset:28672
    ds_read_b64_tr_b16 v[212:213], v25 offset:24576
    ds_read_b64_tr_b16 v[214:215], v25 offset:28672
    ds_read_b64_tr_b16 v[216:217], v26 offset:24576
    ds_read_b64_tr_b16 v[218:219], v26 offset:28672
    ds_read_b64_tr_b16 v[220:221], v27 offset:24576
    ds_read_b64_tr_b16 v[222:223], v27 offset:28672
    s_waitcnt lgkmcnt(14)
    v_mfma_f32_16x16x32_bf16 v[160:163], v[192:195], v[144:147], v[160:163]
    s_waitcnt lgkmcnt(12)
    v_mfma_f32_16x16x32_bf16 v[164:167], v[196:199], v[144:147], v[164:167]
    s_waitcnt lgkmcnt(10)
    v_mfma_f32_16x16x32_bf16 v[168:171], v[200:203], v[144:147], v[168:171]
    s_waitcnt lgkmcnt(8)
    v_mfma_f32_16x16x32_bf16 v[172:175], v[204:207], v[144:147], v[172:175]
    s_waitcnt lgkmcnt(6)
    v_mfma_f32_16x16x32_bf16 v[176:179], v[208:211], v[144:147], v[176:179]
    s_waitcnt lgkmcnt(4)
    v_mfma_f32_16x16x32_bf16 v[180:183], v[212:215], v[144:147], v[180:183]
    s_waitcnt lgkmcnt(2)
    v_mfma_f32_16x16x32_bf16 v[184:187], v[216:219], v[144:147], v[184:187]
    s_waitcnt lgkmcnt(0)
    v_mfma_f32_16x16x32_bf16 v[188:191], v[220:223], v[144:147], v[188:191]
    s_mov_b64 exec, 1
    ds_add_u32 v13, v14 offset:116
    s_mov_b64 exec, -1
    ds_read_b64_tr_b16 v[192:193], v20 offset:0
    ds_read_b64_tr_b16 v[194:195], v20 offset:4096
    ds_read_b64_tr_b16 v[196:197], v21 offset:0
    ds_read_b64_tr_b16 v[198:199], v21 offset:4096
    ds_read_b64_tr_b16 v[200:201], v22 offset:0
    ds_read_b64_tr_b16 v[202:203], v22 offset:4096
    ds_read_b64_tr_b16 v[204:205], v23 offset:0
    ds_read_b64_tr_b16 v[206:207], v23 offset:4096
    ds_read_b64_tr_b16 v[208:209], v24 offset:0
    ds_read_b64_tr_b16 v[210:211], v24 offset:4096
    ds_read_b64_tr_b16 v[212:213], v25 offset:0
    ds_read_b64_tr_b16 v[214:215], v25 offset:4096
    ds_read_b64_tr_b16 v[216:217], v26 offset:0
    ds_read_b64_tr_b16 v[218:219], v26 offset:4096
    ds_read_b64_tr_b16 v[220:221], v27 offset:0
    ds_read_b64_tr_b16 v[222:223], v27 offset:4096
    s_waitcnt lgkmcnt(14)
    v_mfma_f32_16x16x32_bf16 v[160:163], v[192:195], v[148:151], v[160:163]
    s_waitcnt lgkmcnt(12)
    v_mfma_f32_16x16x32_bf16 v[164:167], v[196:199], v[148:151], v[164:167]
    s_waitcnt lgkmcnt(10)
    v_mfma_f32_16x16x32_bf16 v[168:171], v[200:203], v[148:151], v[168:171]
    s_waitcnt lgkmcnt(8)
    v_mfma_f32_16x16x32_bf16 v[172:175], v[204:207], v[148:151], v[172:175]
    s_waitcnt lgkmcnt(6)
    v_mfma_f32_16x16x32_bf16 v[176:179], v[208:211], v[148:151], v[176:179]
    s_waitcnt lgkmcnt(4)
    v_mfma_f32_16x16x32_bf16 v[180:183], v[212:215], v[148:151], v[180:183]
    s_waitcnt lgkmcnt(2)
    v_mfma_f32_16x16x32_bf16 v[184:187], v[216:219], v[148:151], v[184:187]
    s_waitcnt lgkmcnt(0)
    v_mfma_f32_16x16x32_bf16 v[188:191], v[220:223], v[148:151], v[188:191]
    s_waitcnt vmcnt(8)
    ds_read_b64_tr_b16 v[192:193], v20 offset:8192
    ds_read_b64_tr_b16 v[194:195], v20 offset:12288
    ds_read_b64_tr_b16 v[196:197], v21 offset:8192
    ds_read_b64_tr_b16 v[198:199], v21 offset:12288
    ds_read_b64_tr_b16 v[200:201], v22 offset:8192
    ds_read_b64_tr_b16 v[202:203], v22 offset:12288
    ds_read_b64_tr_b16 v[204:205], v23 offset:8192
    ds_read_b64_tr_b16 v[206:207], v23 offset:12288
    ds_read_b64_tr_b16 v[208:209], v24 offset:8192
    ds_read_b64_tr_b16 v[210:211], v24 offset:12288
    ds_read_b64_tr_b16 v[212:213], v25 offset:8192
    ds_read_b64_tr_b16 v[214:215], v25 offset:12288
    ds_read_b64_tr_b16 v[216:217], v26 offset:8192
    ds_read_b64_tr_b16 v[218:219], v26 offset:12288
    ds_read_b64_tr_b16 v[220:221], v27 offset:8192
    ds_read_b64_tr_b16 v[222:223], v27 offset:12288
    s_waitcnt lgkmcnt(14)
    v_mfma_f32_16x16x32_bf16 v[160:163], v[192:195], v[152:155], v[160:163]
    s_waitcnt lgkmcnt(12)
    v_mfma_f32_16x16x32_bf16 v[164:167], v[196:199], v[152:155], v[164:167]
    s_waitcnt lgkmcnt(10)
    v_mfma_f32_16x16x32_bf16 v[168:171], v[200:203], v[152:155], v[168:171]
    s_waitcnt lgkmcnt(8)
    v_mfma_f32_16x16x32_bf16 v[172:175], v[204:207], v[152:155], v[172:175]
    s_waitcnt lgkmcnt(6)
    v_mfma_f32_16x16x32_bf16 v[176:179], v[208:211], v[152:155], v[176:179]
    s_waitcnt lgkmcnt(4)
    v_mfma_f32_16x16x32_bf16 v[180:183], v[212:215], v[152:155], v[180:183]
    s_waitcnt lgkmcnt(2)
    v_mfma_f32_16x16x32_bf16 v[184:187], v[216:219], v[152:155], v[184:187]
    s_waitcnt lgkmcnt(0)
    v_mfma_f32_16x16x32_bf16 v[188:191], v[220:223], v[152:155], v[188:191]
    v_and_b32 v30, 15, v1
    v_mul_u32_u24 v30, 528, v30
    v_lshl_add_u32 v30, v12, 4, v30
    v_add_u32 v30, s32, v30
    v_add_u32 v30, 24576, v30
    s_mov_b32 s40, 0x00ff00ff
    s_mov_b32 s41, 0x00ff00ff
    s_waitcnt vmcnt(0)
    ds_read_b64_tr_b16 v[192:193], v20 offset:16384
    ds_read_b64_tr_b16 v[194:195], v20 offset:20480
    ds_read_b64_tr_b16 v[196:197], v21 offset:16384
    ds_read_b64_tr_b16 v[198:199], v21 offset:20480
    ds_read_b64_tr_b16 v[200:201], v22 offset:16384
    ds_read_b64_tr_b16 v[202:203], v22 offset:20480
    ds_read_b64_tr_b16 v[204:205], v23 offset:16384
    ds_read_b64_tr_b16 v[206:207], v23 offset:20480
    ds_read_b64_tr_b16 v[208:209], v24 offset:16384
    ds_read_b64_tr_b16 v[210:211], v24 offset:20480
    ds_read_b64_tr_b16 v[212:213], v25 offset:16384
    ds_read_b64_tr_b16 v[214:215], v25 offset:20480
    ds_read_b64_tr_b16 v[216:217], v26 offset:16384
    ds_read_b64_tr_b16 v[218:219], v26 offset:20480
    ds_read_b64_tr_b16 v[220:221], v27 offset:16384
    ds_read_b64_tr_b16 v[222:223], v27 offset:20480
    s_waitcnt lgkmcnt(14)
    v_mfma_f32_16x16x32_bf16 v[160:163], v[192:195], v[156:159], v[160:163]
    s_waitcnt lgkmcnt(12)
    v_mfma_f32_16x16x32_bf16 v[164:167], v[196:199], v[156:159], v[164:167]
    s_waitcnt lgkmcnt(10)
    v_mfma_f32_16x16x32_bf16 v[168:171], v[200:203], v[156:159], v[168:171]
    s_waitcnt lgkmcnt(8)
    v_mfma_f32_16x16x32_bf16 v[172:175], v[204:207], v[156:159], v[172:175]
    s_waitcnt lgkmcnt(6)
    v_mfma_f32_16x16x32_bf16 v[176:179], v[208:211], v[156:159], v[176:179]
    s_waitcnt lgkmcnt(4)
    v_mfma_f32_16x16x32_bf16 v[180:183], v[212:215], v[156:159], v[180:183]
    s_waitcnt lgkmcnt(2)
    v_mfma_f32_16x16x32_bf16 v[184:187], v[216:219], v[156:159], v[184:187]
    s_waitcnt lgkmcnt(0)
    v_mfma_f32_16x16x32_bf16 v[188:191], v[220:223], v[156:159], v[188:191]
    s_mov_b64 exec, s[40:41]
    ds_write_b128 v30, v[160:163] offset:0
    ds_write_b128 v30, v[164:167] offset:64
    ds_write_b128 v30, v[168:171] offset:128
    ds_write_b128 v30, v[172:175] offset:192
    ds_write_b128 v30, v[176:179] offset:256
    ds_write_b128 v30, v[180:183] offset:320
    ds_write_b128 v30, v[184:187] offset:384
    ds_write_b128 v30, v[188:191] offset:448
    s_waitcnt lgkmcnt(0)
    s_mov_b64 exec, -1
    s_barrier
    s_waitcnt lgkmcnt(0)
    s_endpgm
L_aux:
    s_setprio 2
    s_sub_u32 s3, s3, 4
    s_lshl_b32 s32, s3, 15
    v_lshlrev_b32 v5, 4, v1
    v_mov_b32 v2, 150272
    v_mov_b32 v3, 1
    v_mov_b32 v16, 0
    v_lshl_add_u32 v9, v1, 2, v2
    ds_write_b32 v9, v16
    v_mov_b32 v32, -1
    v_mov_b32 v33, -1
    v_mov_b32 v34, -1
    v_mov_b32 v35, -1
    v_bfe_u32 v10, v1, 2, 2
    v_lshrrev_b32 v11, 4, v1
    v_and_b32 v14, 3, v1
    v_lshl_add_u32 v11, v11, 2, v14
    v_lshlrev_b32 v10, 11, v10
    v_lshl_add_u32 v8, v11, 3, v10
    s_waitcnt lgkmcnt(0)
    s_mov_b32 s34, s92
    s_mov_b32 s35, s95
    s_lshr_b32 s15, s93, 25
    s_and_b32 s37, s2, 15
    s_lshr_b32 s38, s2, 4
    s_and_b32 s99, s93, 255
    s_cmp_ge_u32 s99, 64
    s_cselect_b32 s33, 1, 0
    s_cmp_ge_u32 s99, 192
    s_cselect_b32 s33, 2, s33
    s_bfe_u32 s36, s93, 0x20008
    s_bfe_u32 s39, s93, 0x6000a
    s_bfe_u32 s101, s93, 0x80010
    s_bfe_u32 s0, s93, 0x10018
    s_and_b32 s63, s94, 255
    s_bfe_u32 s1, s94, 0x80008
    s_lshr_b32 s14, s94, 16
    s_lshl_b32 s40, s36, 9
    s_lshl_b32 s41, s3, 7
    s_add_u32 s40, s40, s41
    v_add_u32 v8, s40, v8
    s_lshl_b32 s40, s3, 11
    v_add_u32 v9, s40, v5
    v_lshl_add_u32 v13, v11, 2, v10
    s_and_b32 s40, s101, 7
    s_lshl_b32 s40, s40, 8
    s_lshl_b32 s41, s3, 6
    s_add_u32 s40, s40, s41
    v_add_u32 v13, s40, v13
    s_waitcnt lgkmcnt(0)
    s_mov_b32 s44, s30
    s_mov_b32 s45, s31
    s_mov_b32 s46, 2829312
    s_mov_b32 s47, 0x20000
    s_cmp_eq_u32 s15, 0
    s_cbranch_scc1 Lnohead_97
    s_cmp_lg_u32 s3, 3
    s_cbranch_scc1 Lnohead_97_b
    s_sub_u32 s41, s15, 32
    s_lshr_b32 s40, s41, 3
    s_mul_i32 s40, s40, 8320
    s_and_b32 s42, s41, 7
    s_lshl_b32 s42, s42, 9
    s_add_u32 s40, s40, s42
    s_add_u32 s40, s40, 2686976
    s_add_u32 s42, s40, 66560
    s_add_u32 s43, s40, 4096
    s_add_u32 s48, s42, 4096
    v_lshrrev_b32 v12, 5, v1
    v_mul_u32_u24 v12, 33280, v12
    v_and_b32 v14, 31, v1
    v_lshl_add_u32 v12, v14, 4, v12
    buffer_store_dwordx4 v[32:35], v12, s[44:47], s40 offen sc1
    buffer_store_dwordx4 v[32:35], v12, s[44:47], s42 offen sc1
    buffer_store_dwordx4 v[32:35], v12, s[44:47], s43 offen sc1
    buffer_store_dwordx4 v[32:35], v12, s[44:47], s48 offen sc1
    s_cmp_lt_u32 s15, 63
    s_cbranch_scc1 Lnohead_97_c
    s_mov_b32 s40, 2828288
    buffer_store_dwordx4 v[32:35], v5, s[44:47], s40 offen sc1
    s_nop 1
Lnohead_97_c:
    s_lshl_b32 s41, s41, 2
    v_mov_b32 v12, s41
    s_barrier
    s_waitcnt vmcnt(0)
    s_mov_b64 exec, 1
    global_store_dword v12, v3, s[28:29] sc1
    s_mov_b64 exec, -1
    s_branch Lnohead_97
Lnohead_97_b:
    s_barrier
Lnohead_97:
    v_mov_b32 v62, v8
    v_and_b32 v10, 15, v1
    v_lshlrev_b32 v63, 3, v10
    v_lshrrev_b32 v10, 5, v1
    v_lshl_add_u32 v63, v10, 2, v63
    s_cmp_eq_u32 s33, 1
    s_cbranch_scc1 L_qx
    global_load_dwordx2 v[16:17], v8, s[22:23]
    global_load_dword v18, v13, s[22:23]
    s_cmp_lt_u32 s99, 224
    s_cbranch_scc1 L_nox
    s_cmp_ge_u32 s3, 2
    s_cbranch_scc1 L_nox
    s_sub_u32 s98, s99, 224
    s_lshl_b32 s98, s98, 1
    s_add_u32 s98, s98, s3
    s_lshr_b32 s40, s98, 4
    s_lshl_b32 s40, s40, 11
    v_add_u32 v9, s40, v5
    s_lshl_b32 s40, s98, 7
    v_add_u32 v10, s40, v63
    global_load_dwordx4 v[24:27], v9, s[4:5]
    global_load_dwordx4 v[28:31], v9, s[4:5] offset:1024
    global_load_dword v19, v10, s[4:5]
    s_branch L_nox
L_qx:
    s_lshl_b32 s40, s3, 11
    v_add_u32 v9, s40, v5
    global_load_dwordx2 v[16:17], v8, s[4:5]
    global_load_dwordx4 v[24:27], v9, s[4:5]
    global_load_dwordx4 v[28:31], v9, s[4:5] offset:1024
L_nox:
    s_cmp_lg_u32 s15, 0
    s_cbranch_scc1 L_nobar
    s_barrier
L_nobar:
    s_mov_b32 s50, 0
    s_mul_i32 s40, s3, 2304
    s_add_u32 s40, s40, 131072
    v_lshrrev_b32 v10, 4, v1
    v_mul_u32_u24 v6, 576, v10
    v_and_b32 v10, 15, v1
    v_lshl_add_u32 v6, v10, 2, v6
    v_add_u32 v6, s40, v6
    s_mul_i32 s40, s3, 1152
    s_add_u32 s40, s40, 131072
    v_lshrrev_b32 v10, 5, v1
    v_mul_u32_u24 v7, 576, v10
    v_and_b32 v10, 31, v1
    v_lshl_add_u32 v7, v10, 4, v7
    v_add_u32 v7, s40, v7
    s_mul_i32 s40, s2, 10496
    s_mul_i32 s41, s3, 2624
    s_add_u32 s41, s40, s41
    buffer_store_dwordx4 v[32:35], v5, s[44:47], s41 offen offset:0 sc1
    buffer_store_dwordx4 v[32:35], v5, s[44:47], s41 offen offset:1024 sc1
    v_cmp_gt_u32 vcc, 36, v1
    s_nop 0
    s_and_b64 exec, exec, vcc
    buffer_store_dwordx4 v[32:35], v5, s[44:47], s41 offen offset:2048 sc1
    s_mov_b64 exec, -1
    s_cmp_lt_u32 s99, 224
    s_cbranch_scc1 Lnrc_100
    s_cmp_ge_u32 s3, 2
    s_cbranch_scc1 Lnrc_100
    s_lshl_b32 s40, s98, 7
    s_add_u32 s40, s40, 2820096
    buffer_store_dword v32, v63, s[44:47], s40 offen sc1
    s_waitcnt vmcnt(4)
    s_branch Lclrd_99
Lnrc_100:
    s_waitcnt vmcnt(3)
Lclrd_99:
    s_cmp_eq_u32 s33, 1
    s_cbranch_scc1 L_roleQ
    s_cmp_lt_u32 s99, 224
    s_cbranch_scc1 Lnr_101
    s_cmp_ge_u32 s3, 2
    s_cbranch_scc1 Lnr_101
    v_lshlrev_b32 v66, 16, v19
    v_and_b32 v67, 0xffff0000, v19
    s_nop 1
Lnr_101:
    v_lshlrev_b32 v32, 16, v16
    v_and_b32 v33, 0xffff0000, v16
    v_lshlrev_b32 v34, 16, v17
    v_and_b32 v35, 0xffff0000, v17
    v_lshlrev_b32 v36, 16, v18
    v_and_b32 v37, 0xffff0000, v18
    v_mul_f32 v48, 0xbfb8aa3b, v32
    v_mul_f32 v49, 0xbfb8aa3b, v33
    v_mul_f32 v50, 0xbfb8aa3b, v34
    v_mul_f32 v51, 0xbfb8aa3b, v35
    v_mul_f32 v52, 0xbfb8aa3b, v36
    v_mul_f32 v53, 0xbfb8aa3b, v37
    v_exp_f32 v48, v48
    v_exp_f32 v49, v49
    v_exp_f32 v50, v50
    v_exp_f32 v51, v51
    v_exp_f32 v52, v52
    v_exp_f32 v53, v53
    v_add_f32 v48, 1.0, v48
    v_add_f32 v49, 1.0, v49
    v_add_f32 v50, 1.0, v50
    v_add_f32 v51, 1.0, v51
    v_add_f32 v52, 1.0, v52
    v_add_f32 v53, 1.0, v53
    v_rcp_f32 v48, v48
    v_rcp_f32 v49, v49
    v_rcp_f32 v50, v50
    v_rcp_f32 v51, v51
    v_rcp_f32 v52, v52
    v_rcp_f32 v53, v53
    v_mul_f32 v32, v32, v48
    v_mul_f32 v33, v33, v49
    v_mul_f32 v34, v34, v50
    v_mul_f32 v35, v35, v51
    v_mul_f32 v36, v36, v52
    v_mul_f32 v37, v37, v53
    v_cvt_pk_bf16_f32 v16, v32, v33
    v_cvt_pk_bf16_f32 v20, v34, v35
    v_cvt_pk_bf16_f32 v56, v36, v37
    v_mov_b32_dpp v17, v16 quad_perm:[1,1,1,1] row_mask:0xf bank_mask:0xf
    v_mov_b32_dpp v18, v16 quad_perm:[2,2,2,2] row_mask:0xf bank_mask:0xf
    v_mov_b32_dpp v19, v16 quad_perm:[3,3,3,3] row_mask:0xf bank_mask:0xf
    v_mov_b32_dpp v16, v16 quad_perm:[0,0,0,0] row_mask:0xf bank_mask:0xf
    v_mov_b32_dpp v21, v20 quad_perm:[1,1,1,1] row_mask:0xf bank_mask:0xf
    v_mov_b32_dpp v22, v20 quad_perm:[2,2,2,2] row_mask:0xf bank_mask:0xf
    v_mov_b32_dpp v23, v20 quad_perm:[3,3,3,3] row_mask:0xf bank_mask:0xf
    v_mov_b32_dpp v20, v20 quad_perm:[0,0,0,0] row_mask:0xf bank_mask:0xf
    v_mov_b32_dpp v57, v56 quad_perm:[1,1,1,1] row_mask:0xf bank_mask:0xf
    v_mov_b32_dpp v58, v56 quad_perm:[2,2,2,2] row_mask:0xf bank_mask:0xf
    v_mov_b32_dpp v59, v56 quad_perm:[3,3,3,3] row_mask:0xf bank_mask:0xf
    v_mov_b32_dpp v56, v56 quad_perm:[0,0,0,0] row_mask:0xf bank_mask:0xf
    v_and_b32 v61, 31, v1
    v_lshlrev_b32 v61, 2, v61
    s_cmp_lg_u32 s3, 3
    s_cbranch_scc1 Lnogo_102
    global_load_dword v60, v61, s[28:29] sc1
Lnogo_102:
    v_lshrrev_b32 v15, 2, v1
    v_lshlrev_b32 v8, 8, v15
    v_and_b32 v15, 7, v15
    v_lshl_add_u32 v8, v15, 5, v8
    v_and_b32 v15, 3, v1
    v_lshl_add_u32 v8, v15, 3, v8
    v_add_u32 v8, s32, v8
    v_xor_b32 v9, 32, v8
    v_xor_b32 v10, 64, v8
    v_xor_b32 v11, 96, v8
    v_xor_b32 v12, 128, v8
    v_xor_b32 v13, 160, v8
    v_xor_b32 v14, 192, v8
    v_xor_b32 v15, 224, v8
    s_mov_b32 s41, 0
    s_nop 0
Lsp_103:
    ds_read_b32 v4, v2 offset:0
    s_add_u32 s41, s41, 1
    s_waitcnt lgkmcnt(0)
    v_readfirstlane_b32 s40, v4
    s_nop 0
    s_cmp_ge_u32 s40, 4
    s_nop 1
    s_cbranch_scc1 Lspd_104
    s_cmp_lt_u32 s41, 131072
    s_cbranch_scc1 Lsp_103
Lspd_104:
    ds_read_b64_tr_b16 v[192:193], v8 offset:0
    ds_read_b64_tr_b16 v[194:195], v8 offset:4096
    ds_read_b64_tr_b16 v[196:197], v9 offset:0
    ds_read_b64_tr_b16 v[198:199], v9 offset:4096
    ds_read_b64_tr_b16 v[200:201], v10 offset:0
    ds_read_b64_tr_b16 v[202:203], v10 offset:4096
    ds_read_b64_tr_b16 v[204:205], v11 offset:0
    ds_read_b64_tr_b16 v[206:207], v11 offset:4096
    ds_read_b64_tr_b16 v[208:209], v12 offset:0
    ds_read_b64_tr_b16 v[210:211], v12 offset:4096
    ds_read_b64_tr_b16 v[212:213], v13 offset:0
    ds_read_b64_tr_b16 v[214:215], v13 offset:4096
    ds_read_b64_tr_b16 v[216:217], v14 offset:0
    ds_read_b64_tr_b16 v[218:219], v14 offset:4096
    ds_read_b64_tr_b16 v[220:221], v15 offset:0
    ds_read_b64_tr_b16 v[222:223], v15 offset:4096
    ds_read_b64_tr_b16 v[224:225], v8 offset:8192
    ds_read_b64_tr_b16 v[226:227], v8 offset:12288
    ds_read_b64_tr_b16 v[228:229], v9 offset:8192
    ds_read_b64_tr_b16 v[230:231], v9 offset:12288
    ds_read_b64_tr_b16 v[232:233], v10 offset:8192
    ds_read_b64_tr_b16 v[234:235], v10 offset:12288
    ds_read_b64_tr_b16 v[236:237], v11 offset:8192
    ds_read_b64_tr_b16 v[238:239], v11 offset:12288
    ds_read_b64_tr_b16 v[240:241], v12 offset:8192
    ds_read_b64_tr_b16 v[242:243], v12 offset:12288
    ds_read_b64_tr_b16 v[244:245], v13 offset:8192
    ds_read_b64_tr_b16 v[246:247], v13 offset:12288
    ds_read_b64_tr_b16 v[248:249], v14 offset:8192
    ds_read_b64_tr_b16 v[250:251], v14 offset:12288
    ds_read_b64_tr_b16 v[252:253], v15 offset:8192
    ds_read_b64_tr_b16 v[254:255], v15 offset:12288
    s_waitcnt lgkmcnt(0)
    s_mov_b64 exec, 1
    ds_add_u32 v2, v3 offset:32
    s_mov_b64 exec, -1
    v_mfma_f32_16x16x32_bf16 v[24:27], v[16:19], v[192:195], 0
    v_mfma_f32_16x16x32_bf16 v[28:31], v[16:19], v[196:199], 0
    v_mfma_f32_16x16x32_bf16 v[32:35], v[16:19], v[200:203], 0
    v_mfma_f32_16x16x32_bf16 v[36:39], v[16:19], v[204:207], 0
    v_mfma_f32_16x16x32_bf16 v[40:43], v[16:19], v[208:211], 0
    v_mfma_f32_16x16x32_bf16 v[44:47], v[16:19], v[212:215], 0
    v_mfma_f32_16x16x32_bf16 v[48:51], v[16:19], v[216:219], 0
    v_mfma_f32_16x16x32_bf16 v[52:55], v[16:19], v[220:223], 0
    v_mfma_f32_16x16x32_bf16 v[24:27], v[20:23], v[224:227], v[24:27]
    v_mfma_f32_16x16x32_bf16 v[28:31], v[20:23], v[228:231], v[28:31]
    v_mfma_f32_16x16x32_bf16 v[32:35], v[20:23], v[232:235], v[32:35]
    v_mfma_f32_16x16x32_bf16 v[36:39], v[20:23], v[236:239], v[36:39]
    v_mfma_f32_16x16x32_bf16 v[40:43], v[20:23], v[240:243], v[40:43]
    v_mfma_f32_16x16x32_bf16 v[44:47], v[20:23], v[244:247], v[44:47]
    v_mfma_f32_16x16x32_bf16 v[48:51], v[20:23], v[248:251], v[48:51]
    v_mfma_f32_16x16x32_bf16 v[52:55], v[20:23], v[252:255], v[52:55]
    s_nop 0
    ds_write_b32 v6, v24 offset:0
    ds_write_b32 v6, v28 offset:64
    ds_write_b32 v6, v32 offset:128
    ds_write_b32 v6, v36 offset:192
    ds_write_b32 v6, v40 offset:256
    ds_write_b32 v6, v44 offset:320
    ds_write_b32 v6, v48 offset:384
    ds_write_b32 v6, v52 offset:448
    s_cmp_lg_u32 s3, 3
    s_cbranch_scc1 Lnogo_107
    s_mov_b32 s41, 0
Lgo_105:
    s_add_u32 s41, s41, 1
    s_waitcnt vmcnt(0)
    v_cmp_ne_u32 vcc, 1, v60
    s_nop 0
    s_cbranch_vccz Lgod_106
    s_sleep 8
    global_load_dword v60, v61, s[28:29] sc1
    s_cmp_lt_u32 s41, 8192
    s_cbranch_scc1 Lgo_105
Lgod_106:
Lnogo_107:
    s_waitcnt vmcnt(0)
    s_add_u32 s50, s50, 4
    s_waitcnt lgkmcnt(0)
    s_mov_b64 exec, 1
    ds_add_u32 v2, v3 offset:76
    s_mov_b64 exec, -1
    s_mov_b32 s41, 0
Lsp_108:
    ds_read_b32 v4, v2 offset:76
    s_add_u32 s41, s41, 1
    s_waitcnt lgkmcnt(0)
    v_readfirstlane_b32 s40, v4
    s_nop 0
    s_cmp_ge_u32 s40, s50
    s_nop 1
    s_cbranch_scc1 Lspd_109
    s_cmp_lt_u32 s41, 131072
    s_cbranch_scc1 Lsp_108
Lspd_109:
    s_cmp_lg_u32 s3, 3
    s_cbranch_scc1 Lnoarr_110
    s_and_b32 s40, s2, 7
    s_lshl_b32 s40, s40, 5
    s_lshr_b32 s41, s2, 3
    s_add_u32 s40, s40, s41
    s_lshl_b32 s40, s40, 2
    s_add_u32 s40, s40, 2828288
    s_getreg_b32 s41, hwreg(HW_REG_XCC_ID, 0, 4)
    s_add_u32 s41, s41, 1
    v_mov_b32 v8, 0
    v_mov_b32 v9, s41
    s_mov_b64 exec, 1
    buffer_store_dword v9, v8, s[44:47], s40 offen sc1
    s_mov_b64 exec, -1
Lnoarr_110:
    s_cmp_eq_u32 s33, 2
    s_cbranch_scc1 L_roleN
    s_cmp_ge_u32 s3, 2
    s_cbranch_scc1 Lnosum_111
    ds_read_b128 v[24:27], v7 offset:0
    ds_read_b128 v[28:31], v7 offset:2304
    ds_read_b128 v[32:35], v7 offset:4608
    ds_read_b128 v[36:39], v7 offset:6912
    s_waitcnt lgkmcnt(0)
    v_pk_add_f32 v[24:25], v[24:25], v[28:29]
    v_pk_add_f32 v[26:27], v[26:27], v[30:31]
    v_pk_add_f32 v[32:33], v[32:33], v[36:37]
    v_pk_add_f32 v[34:35], v[34:35], v[38:39]
    v_pk_add_f32 v[24:25], v[24:25], v[32:33]
    v_pk_add_f32 v[26:27], v[26:27], v[34:35]
    v_min_u32 v24, -2, v24
    v_min_u32 v25, -2, v25
    v_min_u32 v26, -2, v26
    v_min_u32 v27, -2, v27
    s_nop 1
Lnosum_111:
    s_cmp_ge_u32 s3, 2
    s_cbranch_scc1 Lnopub_112
    s_lshl_b32 s40, s36, 1
    s_add_u32 s40, s40, s3
    s_mul_i32 s40, s40, 16640
    s_lshl_b32 s41, s39, 9
    s_add_u32 s40, s40, s41
    s_add_u32 s40, s40, 2686976
    v_lshrrev_b32 v8, 5, v1
    v_mul_u32_u24 v8, 8320, v8
    v_and_b32 v9, 31, v1
    v_lshl_add_u32 v8, v9, 4, v8
    buffer_store_dwordx4 v[24:27], v8, s[44:47], s40 offen sc1
    s_nop 1
Lnopub_112:
    v_lshrrev_b32 v15, 2, v1
    v_lshlrev_b32 v8, 8, v15
    v_and_b32 v15, 7, v15
    s_lshl_b32 s40, s3, 1
    v_xor_b32 v15, s40, v15
    v_lshl_add_u32 v8, v15, 5, v8
    v_and_b32 v15, 3, v1
    v_lshl_add_u32 v8, v15, 3, v8
    v_xor_b32 v9, 32, v8
    v_add_u32 v10, 0x10000, v8
    v_add_u32 v11, 0x10000, v9
    s_mov_b32 s41, 0
    s_nop 0
Lsp_113:
    ds_read_b32 v4, v2 offset:4
    s_add_u32 s41, s41, 1
    s_waitcnt lgkmcnt(0)
    v_readfirstlane_b32 s40, v4
    s_nop 0
    s_cmp_ge_u32 s40, 4
    s_nop 1
    s_cbranch_scc1 Lspd_114
    s_cmp_lt_u32 s41, 131072
    s_cbranch_scc1 Lsp_113
Lspd_114:
    ds_read_b64_tr_b16 v[160:161], v8 offset:16384
    ds_read_b64_tr_b16 v[162:163], v8 offset:20480
    ds_read_b64_tr_b16 v[164:165], v9 offset:16384
    ds_read_b64_tr_b16 v[166:167], v9 offset:20480
    ds_read_b64_tr_b16 v[168:169], v8 offset:49152
    ds_read_b64_tr_b16 v[170:171], v8 offset:53248
    ds_read_b64_tr_b16 v[172:173], v9 offset:49152
    ds_read_b64_tr_b16 v[174:175], v9 offset:53248
    ds_read_b64_tr_b16 v[176:177], v10 offset:16384
    ds_read_b64_tr_b16 v[178:179], v10 offset:20480
    ds_read_b64_tr_b16 v[180:181], v11 offset:16384
    ds_read_b64_tr_b16 v[182:183], v11 offset:20480
    ds_read_b64_tr_b16 v[184:185], v10 offset:49152
    ds_read_b64_tr_b16 v[186:187], v10 offset:53248
    ds_read_b64_tr_b16 v[188:189], v11 offset:49152
    ds_read_b64_tr_b16 v[190:191], v11 offset:53248
    s_waitcnt lgkmcnt(0)
    s_mov_b64 exec, 1
    ds_add_u32 v2, v3 offset:36
    s_mov_b64 exec, -1
    s_cmp_ge_u32 s99, 224
    s_cbranch_scc1 Lpl_115
    v_lshrrev_b32 v15, 2, v1
    v_lshlrev_b32 v8, 8, v15
    v_and_b32 v15, 7, v15
    s_lshl_b32 s40, s3, 1
    v_xor_b32 v15, s40, v15
    v_lshl_add_u32 v8, v15, 5, v8
    v_and_b32 v15, 3, v1
    v_lshl_add_u32 v8, v15, 3, v8
    v_xor_b32 v9, 32, v8
    v_add_u32 v10, 0x10000, v8
    v_add_u32 v11, 0x10000, v9
    s_mov_b32 s41, 0
    s_nop 0
Lsp_117:
    ds_read_b32 v4, v2 offset:16
    s_add_u32 s41, s41, 1
    s_waitcnt lgkmcnt(0)
    v_readfirstlane_b32 s40, v4
    s_nop 0
    s_cmp_ge_u32 s40, 4
    s_nop 1
    s_cbranch_scc1 Lspd_118
    s_cmp_lt_u32 s41, 131072
    s_cbranch_scc1 Lsp_117
Lspd_118:
    ds_read_b64_tr_b16 v[64:65], v8 offset:24576
    ds_read_b64_tr_b16 v[66:67], v8 offset:28672
    ds_read_b64_tr_b16 v[68:69], v9 offset:24576
    ds_read_b64_tr_b16 v[70:71], v9 offset:28672
    ds_read_b64_tr_b16 v[72:73], v8 offset:57344
    ds_read_b64_tr_b16 v[74:75], v8 offset:61440
    ds_read_b64_tr_b16 v[76:77], v9 offset:57344
    ds_read_b64_tr_b16 v[78:79], v9 offset:61440
    ds_read_b64_tr_b16 v[80:81], v10 offset:24576
    ds_read_b64_tr_b16 v[82:83], v10 offset:28672
    ds_read_b64_tr_b16 v[84:85], v11 offset:24576
    ds_read_b64_tr_b16 v[86:87], v11 offset:28672
    ds_read_b64_tr_b16 v[88:89], v10 offset:57344
    ds_read_b64_tr_b16 v[90:91], v10 offset:61440
    ds_read_b64_tr_b16 v[92:93], v11 offset:57344
    ds_read_b64_tr_b16 v[94:95], v11 offset:61440
    s_waitcnt lgkmcnt(0)
    s_mov_b64 exec, 1
    ds_add_u32 v2, v3 offset:48
    s_mov_b64 exec, -1
    s_branch Lpld_116
Lpl_115:
    s_mov_b64 exec, 1
    ds_add_u32 v2, v3 offset:48
    s_mov_b64 exec, -1
Lpld_116:
    s_cmp_eq_u32 s0, 0
    s_cbranch_scc1 Lpl_119
    v_lshrrev_b32 v15, 2, v1
    v_lshlrev_b32 v8, 8, v15
    v_and_b32 v15, 7, v15
    v_lshl_add_u32 v8, v15, 5, v8
    v_and_b32 v15, 3, v1
    v_lshl_add_u32 v8, v15, 3, v8
    v_add_u32 v8, s32, v8
    v_xor_b32 v9, 32, v8
    v_xor_b32 v10, 64, v8
    v_xor_b32 v11, 96, v8
    v_xor_b32 v12, 128, v8
    v_xor_b32 v13, 160, v8
    v_xor_b32 v14, 192, v8
    v_xor_b32 v15, 224, v8
    s_mov_b32 s41, 0
    s_nop 0
Lsp_121:
    ds_read_b32 v4, v2 offset:20
    s_add_u32 s41, s41, 1
    s_waitcnt lgkmcnt(0)
    v_readfirstlane_b32 s40, v4
    s_nop 0
    s_cmp_ge_u32 s40, 4
    s_nop 1
    s_cbranch_scc1 Lspd_122
    s_cmp_lt_u32 s41, 131072
    s_cbranch_scc1 Lsp_121
Lspd_122:
    ds_read_b64_tr_b16 v[192:193], v8 offset:0
    ds_read_b64_tr_b16 v[194:195], v8 offset:4096
    ds_read_b64_tr_b16 v[196:197], v9 offset:0
    ds_read_b64_tr_b16 v[198:199], v9 offset:4096
    ds_read_b64_tr_b16 v[200:201], v10 offset:0
    ds_read_b64_tr_b16 v[202:203], v10 offset:4096
    ds_read_b64_tr_b16 v[204:205], v11 offset:0
    ds_read_b64_tr_b16 v[206:207], v11 offset:4096
    ds_read_b64_tr_b16 v[208:209], v12 offset:0
    ds_read_b64_tr_b16 v[210:211], v12 offset:4096
    ds_read_b64_tr_b16 v[212:213], v13 offset:0
    ds_read_b64_tr_b16 v[214:215], v13 offset:4096
    ds_read_b64_tr_b16 v[216:217], v14 offset:0
    ds_read_b64_tr_b16 v[218:219], v14 offset:4096
    ds_read_b64_tr_b16 v[220:221], v15 offset:0
    ds_read_b64_tr_b16 v[222:223], v15 offset:4096
    s_waitcnt lgkmcnt(0)
    s_mov_b64 exec, 1
    ds_add_u32 v2, v3 offset:52
    s_mov_b64 exec, -1
    s_branch Lpld_120
Lpl_119:
    s_mov_b64 exec, 1
    ds_add_u32 v2, v3 offset:52
    s_mov_b64 exec, -1
Lpld_120:
    s_cmp_ge_u32 s99, 224
    s_cbranch_scc1 Lpl_123
    v_lshrrev_b32 v15, 2, v1
    v_lshlrev_b32 v8, 8, v15
    v_and_b32 v15, 7, v15
    s_lshl_b32 s40, s3, 1
    v_xor_b32 v15, s40, v15
    v_lshl_add_u32 v8, v15, 5, v8
    v_and_b32 v15, 3, v1
    v_lshl_add_u32 v8, v15, 3, v8
    v_xor_b32 v9, 32, v8
    v_add_u32 v10, 0x10000, v8
    v_add_u32 v11, 0x10000, v9
    s_mov_b32 s41, 0
    s_nop 0
Lsp_125:
    ds_read_b32 v4, v2 offset:8
    s_add_u32 s41, s41, 1
    s_waitcnt lgkmcnt(0)
    v_readfirstlane_b32 s40, v4
    s_nop 0
    s_cmp_ge_u32 s40, 4
    s_nop 1
    s_cbranch_scc1 Lspd_126
    s_cmp_lt_u32 s41, 131072
    s_cbranch_scc1 Lsp_125
Lspd_126:
    ds_read_b64_tr_b16 v[96:97], v8 offset:8192
    ds_read_b64_tr_b16 v[98:99], v8 offset:12288
    ds_read_b64_tr_b16 v[100:101], v9 offset:8192
    ds_read_b64_tr_b16 v[102:103], v9 offset:12288
    ds_read_b64_tr_b16 v[104:105], v8 offset:40960
    ds_read_b64_tr_b16 v[106:107], v8 offset:45056
    ds_read_b64_tr_b16 v[108:109], v9 offset:40960
    ds_read_b64_tr_b16 v[110:111], v9 offset:45056
    ds_read_b64_tr_b16 v[112:113], v10 offset:8192
    ds_read_b64_tr_b16 v[114:115], v10 offset:12288
    ds_read_b64_tr_b16 v[116:117], v11 offset:8192
    ds_read_b64_tr_b16 v[118:119], v11 offset:12288
    ds_read_b64_tr_b16 v[120:121], v10 offset:40960
    ds_read_b64_tr_b16 v[122:123], v10 offset:45056
    ds_read_b64_tr_b16 v[124:125], v11 offset:40960
    ds_read_b64_tr_b16 v[126:127], v11 offset:45056
    s_waitcnt lgkmcnt(0)
    s_mov_b64 exec, 1
    ds_add_u32 v2, v3 offset:40
    s_mov_b64 exec, -1
    s_branch Lpld_124
Lpl_123:
    v_lshrrev_b32 v15, 2, v1
    v_lshlrev_b32 v8, 8, v15
    v_and_b32 v15, 7, v15
    v_lshl_add_u32 v8, v15, 5, v8
    v_and_b32 v15, 3, v1
    v_lshl_add_u32 v8, v15, 3, v8
    v_add_u32 v8, s32, v8
    v_xor_b32 v9, 32, v8
    v_xor_b32 v10, 64, v8
    v_xor_b32 v11, 96, v8
    v_xor_b32 v12, 128, v8
    v_xor_b32 v13, 160, v8
    v_xor_b32 v14, 192, v8
    v_xor_b32 v15, 224, v8
    s_mov_b32 s41, 0
    s_nop 0
Lsp_127:
    ds_read_b32 v4, v2 offset:8
    s_add_u32 s41, s41, 1
    s_waitcnt lgkmcnt(0)
    v_readfirstlane_b32 s40, v4
    s_nop 0
    s_cmp_ge_u32 s40, 4
    s_nop 1
    s_cbranch_scc1 Lspd_128
    s_cmp_lt_u32 s41, 131072
    s_cbranch_scc1 Lsp_127
Lspd_128:
    ds_read_b64_tr_b16 v[96:97], v8 offset:8192
    ds_read_b64_tr_b16 v[98:99], v8 offset:12288
    ds_read_b64_tr_b16 v[100:101], v9 offset:8192
    ds_read_b64_tr_b16 v[102:103], v9 offset:12288
    ds_read_b64_tr_b16 v[104:105], v10 offset:8192
    ds_read_b64_tr_b16 v[106:107], v10 offset:12288
    ds_read_b64_tr_b16 v[108:109], v11 offset:8192
    ds_read_b64_tr_b16 v[110:111], v11 offset:12288
    ds_read_b64_tr_b16 v[112:113], v12 offset:8192
    ds_read_b64_tr_b16 v[114:115], v12 offset:12288
    ds_read_b64_tr_b16 v[116:117], v13 offset:8192
    ds_read_b64_tr_b16 v[118:119], v13 offset:12288
    ds_read_b64_tr_b16 v[120:121], v14 offset:8192
    ds_read_b64_tr_b16 v[122:123], v14 offset:12288
    ds_read_b64_tr_b16 v[124:125], v15 offset:8192
    ds_read_b64_tr_b16 v[126:127], v15 offset:12288
    s_waitcnt lgkmcnt(0)
    s_mov_b64 exec, 1
    ds_add_u32 v2, v3 offset:40
    s_mov_b64 exec, -1
Lpld_124:
    s_cmp_ge_u32 s99, 224
    s_cbranch_scc1 Lpl_129
    v_lshrrev_b32 v15, 2, v1
    v_lshlrev_b32 v8, 8, v15
    v_and_b32 v15, 7, v15
    s_lshl_b32 s40, s3, 1
    v_xor_b32 v15, s40, v15
    v_lshl_add_u32 v8, v15, 5, v8
    v_and_b32 v15, 3, v1
    v_lshl_add_u32 v8, v15, 3, v8
    v_xor_b32 v9, 32, v8
    v_add_u32 v10, 0x10000, v8
    v_add_u32 v11, 0x10000, v9
    s_mov_b32 s41, 0
    s_nop 0
Lsp_131:
    ds_read_b32 v4, v2 offset:12
    s_add_u32 s41, s41, 1
    s_waitcnt lgkmcnt(0)
    v_readfirstlane_b32 s40, v4
    s_nop 0
    s_cmp_ge_u32 s40, 4
    s_nop 1
    s_cbranch_scc1 Lspd_132
    s_cmp_lt_u32 s41, 131072
    s_cbranch_scc1 Lsp_131
Lspd_132:
    ds_read_b64_tr_b16 v[128:129], v8 offset:16384
    ds_read_b64_tr_b16 v[130:131], v8 offset:20480
    ds_read_b64_tr_b16 v[132:133], v9 offset:16384
    ds_read_b64_tr_b16 v[134:135], v9 offset:20480
    ds_read_b64_tr_b16 v[136:137], v8 offset:49152
    ds_read_b64_tr_b16 v[138:139], v8 offset:53248
    ds_read_b64_tr_b16 v[140:141], v9 offset:49152
    ds_read_b64_tr_b16 v[142:143], v9 offset:53248
    ds_read_b64_tr_b16 v[144:145], v10 offset:16384
    ds_read_b64_tr_b16 v[146:147], v10 offset:20480
    ds_read_b64_tr_b16 v[148:149], v11 offset:16384
    ds_read_b64_tr_b16 v[150:151], v11 offset:20480
    ds_read_b64_tr_b16 v[152:153], v10 offset:49152
    ds_read_b64_tr_b16 v[154:155], v10 offset:53248
    ds_read_b64_tr_b16 v[156:157], v11 offset:49152
    ds_read_b64_tr_b16 v[158:159], v11 offset:53248
    s_waitcnt lgkmcnt(0)
    s_mov_b64 exec, 1
    ds_add_u32 v2, v3 offset:44
    s_mov_b64 exec, -1
    s_branch Lpld_130
Lpl_129:
    v_lshrrev_b32 v15, 2, v1
    v_lshlrev_b32 v8, 8, v15
    v_and_b32 v15, 7, v15
    v_lshl_add_u32 v8, v15, 5, v8
    v_and_b32 v15, 3, v1
    v_lshl_add_u32 v8, v15, 3, v8
    v_add_u32 v8, s32, v8
    v_xor_b32 v9, 32, v8
    v_xor_b32 v10, 64, v8
    v_xor_b32 v11, 96, v8
    v_xor_b32 v12, 128, v8
    v_xor_b32 v13, 160, v8
    v_xor_b32 v14, 192, v8
    v_xor_b32 v15, 224, v8
    s_mov_b32 s41, 0
    s_nop 0
Lsp_133:
    ds_read_b32 v4, v2 offset:12
    s_add_u32 s41, s41, 1
    s_waitcnt lgkmcnt(0)
    v_readfirstlane_b32 s40, v4
    s_nop 0
    s_cmp_ge_u32 s40, 4
    s_nop 1
    s_cbranch_scc1 Lspd_134
    s_cmp_lt_u32 s41, 131072
    s_cbranch_scc1 Lsp_133
Lspd_134:
    ds_read_b64_tr_b16 v[128:129], v8 offset:16384
    ds_read_b64_tr_b16 v[130:131], v8 offset:20480
    ds_read_b64_tr_b16 v[132:133], v9 offset:16384
    ds_read_b64_tr_b16 v[134:135], v9 offset:20480
    ds_read_b64_tr_b16 v[136:137], v10 offset:16384
    ds_read_b64_tr_b16 v[138:139], v10 offset:20480
    ds_read_b64_tr_b16 v[140:141], v11 offset:16384
    ds_read_b64_tr_b16 v[142:143], v11 offset:20480
    ds_read_b64_tr_b16 v[144:145], v12 offset:16384
    ds_read_b64_tr_b16 v[146:147], v12 offset:20480
    ds_read_b64_tr_b16 v[148:149], v13 offset:16384
    ds_read_b64_tr_b16 v[150:151], v13 offset:20480
    ds_read_b64_tr_b16 v[152:153], v14 offset:16384
    ds_read_b64_tr_b16 v[154:155], v14 offset:20480
    ds_read_b64_tr_b16 v[156:157], v15 offset:16384
    ds_read_b64_tr_b16 v[158:159], v15 offset:20480
    s_waitcnt lgkmcnt(0)
    s_mov_b64 exec, 1
    ds_add_u32 v2, v3 offset:44
    s_mov_b64 exec, -1
Lpld_130:
    s_cmp_lg_u32 s3, 0
    s_cbranch_scc1 Lgb1_135
    s_mov_b32 s40, 2828288
    s_mov_b32 s41, 0
Lg_136:
    buffer_load_dwordx4 v[24:27], v5, s[44:47], s40 offen offset:0 sc1
    s_waitcnt vmcnt(0)
    v_max3_u32 v4, v24, v25, v26
    v_max_u32 v4, v4, v27
    v_cmp_eq_u32 vcc, -1, v4
    s_add_u32 s41, s41, 1
    s_cbranch_vccz Lgd_137
    s_mov_b64 exec, vcc
    s_sleep 8
    s_cmp_lt_u32 s41, 8192
    s_cbranch_scc1 Lg_136
Lgd_137:
    s_mov_b64 exec, -1
    v_xor_b32 v25, v25, v24
    v_xor_b32 v26, v26, v24
    v_xor_b32 v27, v27, v24
    v_or3_b32 v25, v25, v26, v27
    v_mov_b32_dpp v26, v24 row_ror:1 row_mask:0xf bank_mask:0xf
    v_xor_b32 v26, v26, v24
    v_and_b32 v27, 7, v1
    v_cmp_eq_u32 vcc, 0, v27
    s_nop 1
    v_cndmask_b32 v26, v26, 0, vcc
    v_or_b32 v25, v25, v26
    v_cmp_ne_u32 vcc, 0, v25
    s_nop 0
    s_cbranch_vccnz Lgb1_135
    s_mov_b64 exec, 1
    ds_add_u32 v2, v3 offset:108
    s_mov_b64 exec, -1
Lgb1_135:
    s_add_u32 s50, s50, 4
    s_waitcnt lgkmcnt(0)
    s_mov_b64 exec, 1
    ds_add_u32 v2, v3 offset:76
    s_mov_b64 exec, -1
    s_mov_b32 s41, 0
Lsp_138:
    ds_read_b32 v4, v2 offset:76
    s_add_u32 s41, s41, 1
    s_waitcnt lgkmcnt(0)
    v_readfirstlane_b32 s40, v4
    s_nop 0
    s_cmp_ge_u32 s40, s50
    s_nop 1
    s_cbranch_scc1 Lspd_139
    s_cmp_lt_u32 s41, 131072
    s_cbranch_scc1 Lsp_138
Lspd_139:
    s_branch L_common
L_roleN:
    v_lshrrev_b32 v15, 2, v1
    v_lshlrev_b32 v8, 8, v15
    v_and_b32 v15, 7, v15
    s_lshl_b32 s40, s3, 1
    v_xor_b32 v15, s40, v15
    v_lshl_add_u32 v8, v15, 5, v8
    v_and_b32 v15, 3, v1
    v_lshl_add_u32 v8, v15, 3, v8
    v_xor_b32 v9, 32, v8
    v_add_u32 v10, 0x10000, v8
    v_add_u32 v11, 0x10000, v9
    s_mov_b32 s41, 0
    s_nop 0
Lsp_140:
    ds_read_b32 v4, v2 offset:4
    s_add_u32 s41, s41, 1
    s_waitcnt lgkmcnt(0)
    v_readfirstlane_b32 s40, v4
    s_nop 0
    s_cmp_ge_u32 s40, 4
    s_nop 1
    s_cbranch_scc1 Lspd_141
    s_cmp_lt_u32 s41, 131072
    s_cbranch_scc1 Lsp_140
Lspd_141:
    ds_read_b64_tr_b16 v[160:161], v8 offset:16384
    ds_read_b64_tr_b16 v[162:163], v8 offset:20480
    ds_read_b64_tr_b16 v[164:165], v9 offset:16384
    ds_read_b64_tr_b16 v[166:167], v9 offset:20480
    ds_read_b64_tr_b16 v[168:169], v8 offset:49152
    ds_read_b64_tr_b16 v[170:171], v8 offset:53248
    ds_read_b64_tr_b16 v[172:173], v9 offset:49152
    ds_read_b64_tr_b16 v[174:175], v9 offset:53248
    ds_read_b64_tr_b16 v[176:177], v10 offset:16384
    ds_read_b64_tr_b16 v[178:179], v10 offset:20480
    ds_read_b64_tr_b16 v[180:181], v11 offset:16384
    ds_read_b64_tr_b16 v[182:183], v11 offset:20480
    ds_read_b64_tr_b16 v[184:185], v10 offset:49152
    ds_read_b64_tr_b16 v[186:187], v10 offset:53248
    ds_read_b64_tr_b16 v[188:189], v11 offset:49152
    ds_read_b64_tr_b16 v[190:191], v11 offset:53248
    s_waitcnt lgkmcnt(0)
    s_mov_b64 exec, 1
    ds_add_u32 v2, v3 offset:36
    s_mov_b64 exec, -1
    s_cmp_ge_u32 s99, 224
    s_cbranch_scc1 Lpl_142
    v_lshrrev_b32 v15, 2, v1
    v_lshlrev_b32 v8, 8, v15
    v_and_b32 v15, 7, v15
    s_lshl_b32 s40, s3, 1
    v_xor_b32 v15, s40, v15
    v_lshl_add_u32 v8, v15, 5, v8
    v_and_b32 v15, 3, v1
    v_lshl_add_u32 v8, v15, 3, v8
    v_xor_b32 v9, 32, v8
    v_add_u32 v10, 0x10000, v8
    v_add_u32 v11, 0x10000, v9
    s_mov_b32 s41, 0
    s_nop 0
Lsp_144:
    ds_read_b32 v4, v2 offset:16
    s_add_u32 s41, s41, 1
    s_waitcnt lgkmcnt(0)
    v_readfirstlane_b32 s40, v4
    s_nop 0
    s_cmp_ge_u32 s40, 4
    s_nop 1
    s_cbranch_scc1 Lspd_145
    s_cmp_lt_u32 s41, 131072
    s_cbranch_scc1 Lsp_144
Lspd_145:
    ds_read_b64_tr_b16 v[64:65], v8 offset:24576
    ds_read_b64_tr_b16 v[66:67], v8 offset:28672
    ds_read_b64_tr_b16 v[68:69], v9 offset:24576
    ds_read_b64_tr_b16 v[70:71], v9 offset:28672
    ds_read_b64_tr_b16 v[72:73], v8 offset:57344
    ds_read_b64_tr_b16 v[74:75], v8 offset:61440
    ds_read_b64_tr_b16 v[76:77], v9 offset:57344
    ds_read_b64_tr_b16 v[78:79], v9 offset:61440
    ds_read_b64_tr_b16 v[80:81], v10 offset:24576
    ds_read_b64_tr_b16 v[82:83], v10 offset:28672
    ds_read_b64_tr_b16 v[84:85], v11 offset:24576
    ds_read_b64_tr_b16 v[86:87], v11 offset:28672
    ds_read_b64_tr_b16 v[88:89], v10 offset:57344
    ds_read_b64_tr_b16 v[90:91], v10 offset:61440
    ds_read_b64_tr_b16 v[92:93], v11 offset:57344
    ds_read_b64_tr_b16 v[94:95], v11 offset:61440
    s_waitcnt lgkmcnt(0)
    s_mov_b64 exec, 1
    ds_add_u32 v2, v3 offset:48
    s_mov_b64 exec, -1
    s_branch Lpld_143
Lpl_142:
    s_mov_b64 exec, 1
    ds_add_u32 v2, v3 offset:48
    s_mov_b64 exec, -1
Lpld_143:
    s_cmp_eq_u32 s0, 0
    s_cbranch_scc1 Lpl_146
    v_lshrrev_b32 v15, 2, v1
    v_lshlrev_b32 v8, 8, v15
    v_and_b32 v15, 7, v15
    v_lshl_add_u32 v8, v15, 5, v8
    v_and_b32 v15, 3, v1
    v_lshl_add_u32 v8, v15, 3, v8
    v_add_u32 v8, s32, v8
    v_xor_b32 v9, 32, v8
    v_xor_b32 v10, 64, v8
    v_xor_b32 v11, 96, v8
    v_xor_b32 v12, 128, v8
    v_xor_b32 v13, 160, v8
    v_xor_b32 v14, 192, v8
    v_xor_b32 v15, 224, v8
    s_mov_b32 s41, 0
    s_nop 0
Lsp_148:
    ds_read_b32 v4, v2 offset:20
    s_add_u32 s41, s41, 1
    s_waitcnt lgkmcnt(0)
    v_readfirstlane_b32 s40, v4
    s_nop 0
    s_cmp_ge_u32 s40, 4
    s_nop 1
    s_cbranch_scc1 Lspd_149
    s_cmp_lt_u32 s41, 131072
    s_cbranch_scc1 Lsp_148
Lspd_149:
    ds_read_b64_tr_b16 v[192:193], v8 offset:0
    ds_read_b64_tr_b16 v[194:195], v8 offset:4096
    ds_read_b64_tr_b16 v[196:197], v9 offset:0
    ds_read_b64_tr_b16 v[198:199], v9 offset:4096
    ds_read_b64_tr_b16 v[200:201], v10 offset:0
    ds_read_b64_tr_b16 v[202:203], v10 offset:4096
    ds_read_b64_tr_b16 v[204:205], v11 offset:0
    ds_read_b64_tr_b16 v[206:207], v11 offset:4096
    ds_read_b64_tr_b16 v[208:209], v12 offset:0
    ds_read_b64_tr_b16 v[210:211], v12 offset:4096
    ds_read_b64_tr_b16 v[212:213], v13 offset:0
    ds_read_b64_tr_b16 v[214:215], v13 offset:4096
    ds_read_b64_tr_b16 v[216:217], v14 offset:0
    ds_read_b64_tr_b16 v[218:219], v14 offset:4096
    ds_read_b64_tr_b16 v[220:221], v15 offset:0
    ds_read_b64_tr_b16 v[222:223], v15 offset:4096
    s_waitcnt lgkmcnt(0)
    s_mov_b64 exec, 1
    ds_add_u32 v2, v3 offset:52
    s_mov_b64 exec, -1
    s_branch Lpld_147
Lpl_146:
    s_mov_b64 exec, 1
    ds_add_u32 v2, v3 offset:52
    s_mov_b64 exec, -1
Lpld_147:
    s_cmp_ge_u32 s99, 224
    s_cbranch_scc1 Lpl_150
    v_lshrrev_b32 v15, 2, v1
    v_lshlrev_b32 v8, 8, v15
    v_and_b32 v15, 7, v15
    s_lshl_b32 s40, s3, 1
    v_xor_b32 v15, s40, v15
    v_lshl_add_u32 v8, v15, 5, v8
    v_and_b32 v15, 3, v1
    v_lshl_add_u32 v8, v15, 3, v8
    v_xor_b32 v9, 32, v8
    v_add_u32 v10, 0x10000, v8
    v_add_u32 v11, 0x10000, v9
    s_mov_b32 s41, 0
    s_nop 0
Lsp_152:
    ds_read_b32 v4, v2 offset:8
    s_add_u32 s41, s41, 1
    s_waitcnt lgkmcnt(0)
    v_readfirstlane_b32 s40, v4
    s_nop 0
    s_cmp_ge_u32 s40, 4
    s_nop 1
    s_cbranch_scc1 Lspd_153
    s_cmp_lt_u32 s41, 131072
    s_cbranch_scc1 Lsp_152
Lspd_153:
    ds_read_b64_tr_b16 v[96:97], v8 offset:8192
    ds_read_b64_tr_b16 v[98:99], v8 offset:12288
    ds_read_b64_tr_b16 v[100:101], v9 offset:8192
    ds_read_b64_tr_b16 v[102:103], v9 offset:12288
    ds_read_b64_tr_b16 v[104:105], v8 offset:40960
    ds_read_b64_tr_b16 v[106:107], v8 offset:45056
    ds_read_b64_tr_b16 v[108:109], v9 offset:40960
    ds_read_b64_tr_b16 v[110:111], v9 offset:45056
    ds_read_b64_tr_b16 v[112:113], v10 offset:8192
    ds_read_b64_tr_b16 v[114:115], v10 offset:12288
    ds_read_b64_tr_b16 v[116:117], v11 offset:8192
    ds_read_b64_tr_b16 v[118:119], v11 offset:12288
    ds_read_b64_tr_b16 v[120:121], v10 offset:40960
    ds_read_b64_tr_b16 v[122:123], v10 offset:45056
    ds_read_b64_tr_b16 v[124:125], v11 offset:40960
    ds_read_b64_tr_b16 v[126:127], v11 offset:45056
    s_waitcnt lgkmcnt(0)
    s_mov_b64 exec, 1
    ds_add_u32 v2, v3 offset:40
    s_mov_b64 exec, -1
    s_branch Lpld_151
Lpl_150:
    v_lshrrev_b32 v15, 2, v1
    v_lshlrev_b32 v8, 8, v15
    v_and_b32 v15, 7, v15
    v_lshl_add_u32 v8, v15, 5, v8
    v_and_b32 v15, 3, v1
    v_lshl_add_u32 v8, v15, 3, v8
    v_add_u32 v8, s32, v8
    v_xor_b32 v9, 32, v8
    v_xor_b32 v10, 64, v8
    v_xor_b32 v11, 96, v8
    v_xor_b32 v12, 128, v8
    v_xor_b32 v13, 160, v8
    v_xor_b32 v14, 192, v8
    v_xor_b32 v15, 224, v8
    s_mov_b32 s41, 0
    s_nop 0
Lsp_154:
    ds_read_b32 v4, v2 offset:8
    s_add_u32 s41, s41, 1
    s_waitcnt lgkmcnt(0)
    v_readfirstlane_b32 s40, v4
    s_nop 0
    s_cmp_ge_u32 s40, 4
    s_nop 1
    s_cbranch_scc1 Lspd_155
    s_cmp_lt_u32 s41, 131072
    s_cbranch_scc1 Lsp_154
Lspd_155:
    ds_read_b64_tr_b16 v[96:97], v8 offset:8192
    ds_read_b64_tr_b16 v[98:99], v8 offset:12288
    ds_read_b64_tr_b16 v[100:101], v9 offset:8192
    ds_read_b64_tr_b16 v[102:103], v9 offset:12288
    ds_read_b64_tr_b16 v[104:105], v10 offset:8192
    ds_read_b64_tr_b16 v[106:107], v10 offset:12288
    ds_read_b64_tr_b16 v[108:109], v11 offset:8192
    ds_read_b64_tr_b16 v[110:111], v11 offset:12288
    ds_read_b64_tr_b16 v[112:113], v12 offset:8192
    ds_read_b64_tr_b16 v[114:115], v12 offset:12288
    ds_read_b64_tr_b16 v[116:117], v13 offset:8192
    ds_read_b64_tr_b16 v[118:119], v13 offset:12288
    ds_read_b64_tr_b16 v[120:121], v14 offset:8192
    ds_read_b64_tr_b16 v[122:123], v14 offset:12288
    ds_read_b64_tr_b16 v[124:125], v15 offset:8192
    ds_read_b64_tr_b16 v[126:127], v15 offset:12288
    s_waitcnt lgkmcnt(0)
    s_mov_b64 exec, 1
    ds_add_u32 v2, v3 offset:40
    s_mov_b64 exec, -1
Lpld_151:
    s_cmp_ge_u32 s99, 224
    s_cbranch_scc1 Lpl_156
    v_lshrrev_b32 v15, 2, v1
    v_lshlrev_b32 v8, 8, v15
    v_and_b32 v15, 7, v15
    s_lshl_b32 s40, s3, 1
    v_xor_b32 v15, s40, v15
    v_lshl_add_u32 v8, v15, 5, v8
    v_and_b32 v15, 3, v1
    v_lshl_add_u32 v8, v15, 3, v8
    v_xor_b32 v9, 32, v8
    v_add_u32 v10, 0x10000, v8
    v_add_u32 v11, 0x10000, v9
    s_mov_b32 s41, 0
    s_nop 0
Lsp_158:
    ds_read_b32 v4, v2 offset:12
    s_add_u32 s41, s41, 1
    s_waitcnt lgkmcnt(0)
    v_readfirstlane_b32 s40, v4
    s_nop 0
    s_cmp_ge_u32 s40, 4
    s_nop 1
    s_cbranch_scc1 Lspd_159
    s_cmp_lt_u32 s41, 131072
    s_cbranch_scc1 Lsp_158
Lspd_159:
    ds_read_b64_tr_b16 v[128:129], v8 offset:16384
    ds_read_b64_tr_b16 v[130:131], v8 offset:20480
    ds_read_b64_tr_b16 v[132:133], v9 offset:16384
    ds_read_b64_tr_b16 v[134:135], v9 offset:20480
    ds_read_b64_tr_b16 v[136:137], v8 offset:49152
    ds_read_b64_tr_b16 v[138:139], v8 offset:53248
    ds_read_b64_tr_b16 v[140:141], v9 offset:49152
    ds_read_b64_tr_b16 v[142:143], v9 offset:53248
    ds_read_b64_tr_b16 v[144:145], v10 offset:16384
    ds_read_b64_tr_b16 v[146:147], v10 offset:20480
    ds_read_b64_tr_b16 v[148:149], v11 offset:16384
    ds_read_b64_tr_b16 v[150:151], v11 offset:20480
    ds_read_b64_tr_b16 v[152:153], v10 offset:49152
    ds_read_b64_tr_b16 v[154:155], v10 offset:53248
    ds_read_b64_tr_b16 v[156:157], v11 offset:49152
    ds_read_b64_tr_b16 v[158:159], v11 offset:53248
    s_waitcnt lgkmcnt(0)
    s_mov_b64 exec, 1
    ds_add_u32 v2, v3 offset:44
    s_mov_b64 exec, -1
    s_branch Lpld_157
Lpl_156:
    v_lshrrev_b32 v15, 2, v1
    v_lshlrev_b32 v8, 8, v15
    v_and_b32 v15, 7, v15
    v_lshl_add_u32 v8, v15, 5, v8
    v_and_b32 v15, 3, v1
    v_lshl_add_u32 v8, v15, 3, v8
    v_add_u32 v8, s32, v8
    v_xor_b32 v9, 32, v8
    v_xor_b32 v10, 64, v8
    v_xor_b32 v11, 96, v8
    v_xor_b32 v12, 128, v8
    v_xor_b32 v13, 160, v8
    v_xor_b32 v14, 192, v8
    v_xor_b32 v15, 224, v8
    s_mov_b32 s41, 0
    s_nop 0
Lsp_160:
    ds_read_b32 v4, v2 offset:12
    s_add_u32 s41, s41, 1
    s_waitcnt lgkmcnt(0)
    v_readfirstlane_b32 s40, v4
    s_nop 0
    s_cmp_ge_u32 s40, 4
    s_nop 1
    s_cbranch_scc1 Lspd_161
    s_cmp_lt_u32 s41, 131072
    s_cbranch_scc1 Lsp_160
Lspd_161:
    ds_read_b64_tr_b16 v[128:129], v8 offset:16384
    ds_read_b64_tr_b16 v[130:131], v8 offset:20480
    ds_read_b64_tr_b16 v[132:133], v9 offset:16384
    ds_read_b64_tr_b16 v[134:135], v9 offset:20480
    ds_read_b64_tr_b16 v[136:137], v10 offset:16384
    ds_read_b64_tr_b16 v[138:139], v10 offset:20480
    ds_read_b64_tr_b16 v[140:141], v11 offset:16384
    ds_read_b64_tr_b16 v[142:143], v11 offset:20480
    ds_read_b64_tr_b16 v[144:145], v12 offset:16384
    ds_read_b64_tr_b16 v[146:147], v12 offset:20480
    ds_read_b64_tr_b16 v[148:149], v13 offset:16384
    ds_read_b64_tr_b16 v[150:151], v13 offset:20480
    ds_read_b64_tr_b16 v[152:153], v14 offset:16384
    ds_read_b64_tr_b16 v[154:155], v14 offset:20480
    ds_read_b64_tr_b16 v[156:157], v15 offset:16384
    ds_read_b64_tr_b16 v[158:159], v15 offset:20480
    s_waitcnt lgkmcnt(0)
    s_mov_b64 exec, 1
    ds_add_u32 v2, v3 offset:44
    s_mov_b64 exec, -1
Lpld_157:
    s_cmp_lg_u32 s3, 0
    s_cbranch_scc1 Lgb1_162
    s_mov_b32 s40, 2828288
    s_mov_b32 s41, 0
Lg_163:
    buffer_load_dwordx4 v[24:27], v5, s[44:47], s40 offen offset:0 sc1
    s_waitcnt vmcnt(0)
    v_max3_u32 v4, v24, v25, v26
    v_max_u32 v4, v4, v27
    v_cmp_eq_u32 vcc, -1, v4
    s_add_u32 s41, s41, 1
    s_cbranch_vccz Lgd_164
    s_mov_b64 exec, vcc
    s_sleep 8
    s_cmp_lt_u32 s41, 8192
    s_cbranch_scc1 Lg_163
Lgd_164:
    s_mov_b64 exec, -1
    v_xor_b32 v25, v25, v24
    v_xor_b32 v26, v26, v24
    v_xor_b32 v27, v27, v24
    v_or3_b32 v25, v25, v26, v27
    v_mov_b32_dpp v26, v24 row_ror:1 row_mask:0xf bank_mask:0xf
    v_xor_b32 v26, v26, v24
    v_and_b32 v27, 7, v1
    v_cmp_eq_u32 vcc, 0, v27
    s_nop 1
    v_cndmask_b32 v26, v26, 0, vcc
    v_or_b32 v25, v25, v26
    v_cmp_ne_u32 vcc, 0, v25
    s_nop 0
    s_cbranch_vccnz Lgb1_162
    s_mov_b64 exec, 1
    ds_add_u32 v2, v3 offset:108
    s_mov_b64 exec, -1
Lgb1_162:
    s_add_u32 s50, s50, 4
    s_waitcnt lgkmcnt(0)
    s_mov_b64 exec, 1
    ds_add_u32 v2, v3 offset:76
    s_mov_b64 exec, -1
    s_mov_b32 s41, 0
Lsp_165:
    ds_read_b32 v4, v2 offset:76
    s_add_u32 s41, s41, 1
    s_waitcnt lgkmcnt(0)
    v_readfirstlane_b32 s40, v4
    s_nop 0
    s_cmp_ge_u32 s40, s50
    s_nop 1
    s_cbranch_scc1 Lspd_166
    s_cmp_lt_u32 s41, 131072
    s_cbranch_scc1 Lsp_165
Lspd_166:
    s_cmp_ge_u32 s3, 2
    s_cbranch_scc1 Lnosum_167
    ds_read_b128 v[24:27], v7 offset:0
    ds_read_b128 v[28:31], v7 offset:2304
    ds_read_b128 v[32:35], v7 offset:4608
    ds_read_b128 v[36:39], v7 offset:6912
    s_waitcnt lgkmcnt(0)
    v_pk_add_f32 v[24:25], v[24:25], v[28:29]
    v_pk_add_f32 v[26:27], v[26:27], v[30:31]
    v_pk_add_f32 v[32:33], v[32:33], v[36:37]
    v_pk_add_f32 v[34:35], v[34:35], v[38:39]
    v_pk_add_f32 v[224:225], v[24:25], v[32:33]
    v_pk_add_f32 v[226:227], v[26:27], v[34:35]
    v_min_u32 v224, -2, v224
    v_min_u32 v225, -2, v225
    v_min_u32 v226, -2, v226
    v_min_u32 v227, -2, v227
    s_nop 1
Lnosum_167:
    s_cmp_lt_u32 s99, 224
    s_cbranch_scc1 Lnoj2_168
    s_add_u32 s50, s50, 4
    s_waitcnt lgkmcnt(0)
    s_mov_b64 exec, 1
    ds_add_u32 v2, v3 offset:76
    s_mov_b64 exec, -1
    s_mov_b32 s41, 0
Lsp_169:
    ds_read_b32 v4, v2 offset:76
    s_add_u32 s41, s41, 1
    s_waitcnt lgkmcnt(0)
    v_readfirstlane_b32 s40, v4
    s_nop 0
    s_cmp_ge_u32 s40, s50
    s_nop 1
    s_cbranch_scc1 Lspd_170
    s_cmp_lt_u32 s41, 131072
    s_cbranch_scc1 Lsp_169
Lspd_170:
    v_mfma_f32_16x16x32_bf16 v[24:27], v[16:19], v[96:99], 0
    v_mfma_f32_16x16x32_bf16 v[28:31], v[16:19], v[100:103], 0
    v_mfma_f32_16x16x32_bf16 v[32:35], v[16:19], v[104:107], 0
    v_mfma_f32_16x16x32_bf16 v[36:39], v[16:19], v[108:111], 0
    v_mfma_f32_16x16x32_bf16 v[40:43], v[16:19], v[112:115], 0
    v_mfma_f32_16x16x32_bf16 v[44:47], v[16:19], v[116:119], 0
    v_mfma_f32_16x16x32_bf16 v[48:51], v[16:19], v[120:123], 0
    v_mfma_f32_16x16x32_bf16 v[52:55], v[16:19], v[124:127], 0
    v_mfma_f32_16x16x32_bf16 v[24:27], v[20:23], v[128:131], v[24:27]
    v_mfma_f32_16x16x32_bf16 v[28:31], v[20:23], v[132:135], v[28:31]
    v_mfma_f32_16x16x32_bf16 v[32:35], v[20:23], v[136:139], v[32:35]
    v_mfma_f32_16x16x32_bf16 v[36:39], v[20:23], v[140:143], v[36:39]
    v_mfma_f32_16x16x32_bf16 v[40:43], v[20:23], v[144:147], v[40:43]
    v_mfma_f32_16x16x32_bf16 v[44:47], v[20:23], v[148:151], v[44:47]
    v_mfma_f32_16x16x32_bf16 v[48:51], v[20:23], v[152:155], v[48:51]
    v_mfma_f32_16x16x32_bf16 v[52:55], v[20:23], v[156:159], v[52:55]
    s_nop 0
    ds_write_b32 v6, v24 offset:0
    ds_write_b32 v6, v28 offset:64
    ds_write_b32 v6, v32 offset:128
    ds_write_b32 v6, v36 offset:192
    ds_write_b32 v6, v40 offset:256
    ds_write_b32 v6, v44 offset:320
    ds_write_b32 v6, v48 offset:384
    ds_write_b32 v6, v52 offset:448
    s_add_u32 s50, s50, 4
    s_waitcnt lgkmcnt(0)
    s_mov_b64 exec, 1
    ds_add_u32 v2, v3 offset:76
    s_mov_b64 exec, -1
    s_mov_b32 s41, 0
Lsp_171:
    ds_read_b32 v4, v2 offset:76
    s_add_u32 s41, s41, 1
    s_waitcnt lgkmcnt(0)
    v_readfirstlane_b32 s40, v4
    s_nop 0
    s_cmp_ge_u32 s40, s50
    s_nop 1
    s_cbranch_scc1 Lspd_172
    s_cmp_lt_u32 s41, 131072
    s_cbranch_scc1 Lsp_171
Lspd_172:
    s_cmp_ge_u32 s3, 2
    s_cbranch_scc1 Lnosum_173
    ds_read_b128 v[24:27], v7 offset:0
    ds_read_b128 v[28:31], v7 offset:2304
    ds_read_b128 v[32:35], v7 offset:4608
    ds_read_b128 v[36:39], v7 offset:6912
    s_waitcnt lgkmcnt(0)
    v_pk_add_f32 v[24:25], v[24:25], v[28:29]
    v_pk_add_f32 v[26:27], v[26:27], v[30:31]
    v_pk_add_f32 v[32:33], v[32:33], v[36:37]
    v_pk_add_f32 v[34:35], v[34:35], v[38:39]
    v_pk_add_f32 v[228:229], v[24:25], v[32:33]
    v_pk_add_f32 v[230:231], v[26:27], v[34:35]
    v_min_u32 v228, -2, v228
    v_min_u32 v229, -2, v229
    v_min_u32 v230, -2, v230
    v_min_u32 v231, -2, v231
    s_nop 1
Lnosum_173:
Lnoj2_168:
    s_branch L_common
L_roleQ:
    v_lshlrev_b32 v32, 16, v24
    v_and_b32 v33, 0xffff0000, v24
    v_lshlrev_b32 v34, 16, v25
    v_and_b32 v35, 0xffff0000, v25
    v_lshlrev_b32 v36, 16, v26
    v_and_b32 v37, 0xffff0000, v26
    v_lshlrev_b32 v38, 16, v27
    v_and_b32 v39, 0xffff0000, v27
    v_lshlrev_b32 v40, 16, v28
    v_and_b32 v41, 0xffff0000, v28
    v_lshlrev_b32 v42, 16, v29
    v_and_b32 v43, 0xffff0000, v29
    v_lshlrev_b32 v44, 16, v30
    v_and_b32 v45, 0xffff0000, v30
    v_lshlrev_b32 v46, 16, v31
    v_and_b32 v47, 0xffff0000, v31
    v_add_f32 v24, v32, v33
    v_add_f32 v26, v34, v35
    v_add_f32 v24, v24, v36
    v_add_f32 v26, v26, v37
    v_add_f32 v24, v24, v38
    v_add_f32 v26, v26, v39
    v_add_f32 v24, v24, v40
    v_add_f32 v26, v26, v41
    v_add_f32 v24, v24, v42
    v_add_f32 v26, v26, v43
    v_add_f32 v24, v24, v44
    v_add_f32 v26, v26, v45
    v_add_f32 v24, v24, v46
    v_add_f32 v26, v26, v47
    v_add_f32 v24, v24, v26
    s_nop 1
    v_add_f32_dpp v24, v24, v24 row_ror:8 row_mask:0xf bank_mask:0xf
    s_nop 1
    v_add_f32_dpp v24, v24, v24 row_ror:4 row_mask:0xf bank_mask:0xf
    s_nop 1
    v_add_f32_dpp v24, v24, v24 row_ror:2 row_mask:0xf bank_mask:0xf
    s_nop 1
    v_add_f32_dpp v24, v24, v24 row_ror:1 row_mask:0xf bank_mask:0xf
    v_mov_b32 v26, v24
    s_nop 1
    v_permlane16_swap_b32 v26, v24
    v_add_f32 v24, v24, v26
    v_mov_b32 v26, v24
    s_nop 1
    v_permlane32_swap_b32 v26, v24
    v_add_f32 v24, v24, v26
    v_mul_f32 v24, 0x3a800000, v24
    v_sub_f32 v26, v32, v24
    v_sub_f32 v27, v33, v24
    v_mul_f32 v25, v26, v26
    v_mul_f32 v28, v27, v27
    v_sub_f32 v26, v34, v24
    v_sub_f32 v27, v35, v24
    v_fmac_f32 v25, v26, v26
    v_fmac_f32 v28, v27, v27
    v_sub_f32 v26, v36, v24
    v_sub_f32 v27, v37, v24
    v_fmac_f32 v25, v26, v26
    v_fmac_f32 v28, v27, v27
    v_sub_f32 v26, v38, v24
    v_sub_f32 v27, v39, v24
    v_fmac_f32 v25, v26, v26
    v_fmac_f32 v28, v27, v27
    v_sub_f32 v26, v40, v24
    v_sub_f32 v27, v41, v24
    v_fmac_f32 v25, v26, v26
    v_fmac_f32 v28, v27, v27
    v_sub_f32 v26, v42, v24
    v_sub_f32 v27, v43, v24
    v_fmac_f32 v25, v26, v26
    v_fmac_f32 v28, v27, v27
    v_sub_f32 v26, v44, v24
    v_sub_f32 v27, v45, v24
    v_fmac_f32 v25, v26, v26
    v_fmac_f32 v28, v27, v27
    v_sub_f32 v26, v46, v24
    v_sub_f32 v27, v47, v24
    v_fmac_f32 v25, v26, v26
    v_fmac_f32 v28, v27, v27
    v_add_f32 v25, v25, v28
    s_nop 1
    v_add_f32_dpp v25, v25, v25 row_ror:8 row_mask:0xf bank_mask:0xf
    s_nop 1
    v_add_f32_dpp v25, v25, v25 row_ror:4 row_mask:0xf bank_mask:0xf
    s_nop 1
    v_add_f32_dpp v25, v25, v25 row_ror:2 row_mask:0xf bank_mask:0xf
    s_nop 1
    v_add_f32_dpp v25, v25, v25 row_ror:1 row_mask:0xf bank_mask:0xf
    v_mov_b32 v26, v25
    s_nop 1
    v_permlane16_swap_b32 v26, v25
    v_add_f32 v25, v25, v26
    v_mov_b32 v26, v25
    s_nop 1
    v_permlane32_swap_b32 v26, v25
    v_add_f32 v25, v25, v26
    v_mul_f32 v25, 0x3a800000, v25
    v_cvt_pk_bf16_f32 v24, v24, v24
    v_lshlrev_b32 v24, 16, v24
    v_cvt_pk_bf16_f32 v25, v25, v25
    v_lshlrev_b32 v25, 16, v25
    v_add_f32 v25, 0x3727c5ac, v25
    v_cvt_pk_bf16_f32 v25, v25, v25
    v_lshlrev_b32 v25, 16, v25
    v_sqrt_f32 v25, v25
    s_nop 0
    v_cvt_pk_bf16_f32 v25, v25, v25
    v_lshlrev_b32 v25, 16, v25
    v_rcp_f32 v25, v25
    s_lshl_b32 s40, s3, 3
    s_add_u32 s40, s40, 150016
    v_mov_b32 v8, s40
    ds_write_b64 v8, v[24:25]
    v_and_b32 v61, 31, v1
    v_lshlrev_b32 v61, 2, v61
    s_cmp_lg_u32 s3, 3
    s_cbranch_scc1 Lnogo_174
    global_load_dword v60, v61, s[28:29] sc1
Lnogo_174:
    v_lshrrev_b32 v15, 2, v1
    v_lshlrev_b32 v8, 8, v15
    v_and_b32 v15, 7, v15
    v_lshl_add_u32 v8, v15, 5, v8
    v_and_b32 v15, 3, v1
    v_lshl_add_u32 v8, v15, 3, v8
    v_add_u32 v8, s32, v8
    v_xor_b32 v9, 32, v8
    v_xor_b32 v10, 64, v8
    v_xor_b32 v11, 96, v8
    v_xor_b32 v12, 128, v8
    v_xor_b32 v13, 160, v8
    v_xor_b32 v14, 192, v8
    v_xor_b32 v15, 224, v8
    s_mov_b32 s41, 0
    s_nop 0
Lsp_175:
    ds_read_b32 v4, v2 offset:0
    s_add_u32 s41, s41, 1
    s_waitcnt lgkmcnt(0)
    v_readfirstlane_b32 s40, v4
    s_nop 0
    s_cmp_ge_u32 s40, 4
    s_nop 1
    s_cbranch_scc1 Lspd_176
    s_cmp_lt_u32 s41, 131072
    s_cbranch_scc1 Lsp_175
Lspd_176:
    ds_read_b64_tr_b16 v[192:193], v8 offset:0
    ds_read_b64_tr_b16 v[194:195], v8 offset:4096
    ds_read_b64_tr_b16 v[196:197], v9 offset:0
    ds_read_b64_tr_b16 v[198:199], v9 offset:4096
    ds_read_b64_tr_b16 v[200:201], v10 offset:0
    ds_read_b64_tr_b16 v[202:203], v10 offset:4096
    ds_read_b64_tr_b16 v[204:205], v11 offset:0
    ds_read_b64_tr_b16 v[206:207], v11 offset:4096
    ds_read_b64_tr_b16 v[208:209], v12 offset:0
    ds_read_b64_tr_b16 v[210:211], v12 offset:4096
    ds_read_b64_tr_b16 v[212:213], v13 offset:0
    ds_read_b64_tr_b16 v[214:215], v13 offset:4096
    ds_read_b64_tr_b16 v[216:217], v14 offset:0
    ds_read_b64_tr_b16 v[218:219], v14 offset:4096
    ds_read_b64_tr_b16 v[220:221], v15 offset:0
    ds_read_b64_tr_b16 v[222:223], v15 offset:4096
    ds_read_b64_tr_b16 v[224:225], v8 offset:8192
    ds_read_b64_tr_b16 v[226:227], v8 offset:12288
    ds_read_b64_tr_b16 v[228:229], v9 offset:8192
    ds_read_b64_tr_b16 v[230:231], v9 offset:12288
    ds_read_b64_tr_b16 v[232:233], v10 offset:8192
    ds_read_b64_tr_b16 v[234:235], v10 offset:12288
    ds_read_b64_tr_b16 v[236:237], v11 offset:8192
    ds_read_b64_tr_b16 v[238:239], v11 offset:12288
    ds_read_b64_tr_b16 v[240:241], v12 offset:8192
    ds_read_b64_tr_b16 v[242:243], v12 offset:12288
    ds_read_b64_tr_b16 v[244:245], v13 offset:8192
    ds_read_b64_tr_b16 v[246:247], v13 offset:12288
    ds_read_b64_tr_b16 v[248:249], v14 offset:8192
    ds_read_b64_tr_b16 v[250:251], v14 offset:12288
    ds_read_b64_tr_b16 v[252:253], v15 offset:8192
    ds_read_b64_tr_b16 v[254:255], v15 offset:12288
    s_waitcnt lgkmcnt(0)
    s_mov_b64 exec, 1
    ds_add_u32 v2, v3 offset:32
    s_mov_b64 exec, -1
    s_cmp_lg_u32 s3, 3
    s_cbranch_scc1 Lnogo_179
    s_mov_b32 s41, 0
Lgo_177:
    s_add_u32 s41, s41, 1
    s_waitcnt vmcnt(0)
    v_cmp_ne_u32 vcc, 1, v60
    s_nop 0
    s_cbranch_vccz Lgod_178
    s_sleep 8
    global_load_dword v60, v61, s[28:29] sc1
    s_cmp_lt_u32 s41, 8192
    s_cbranch_scc1 Lgo_177
Lgod_178:
Lnogo_179:
    s_waitcnt vmcnt(0)
    s_add_u32 s50, s50, 4
    s_waitcnt lgkmcnt(0)
    s_mov_b64 exec, 1
    ds_add_u32 v2, v3 offset:76
    s_mov_b64 exec, -1
    s_mov_b32 s41, 0
Lsp_180:
    ds_read_b32 v4, v2 offset:76
    s_add_u32 s41, s41, 1
    s_waitcnt lgkmcnt(0)
    v_readfirstlane_b32 s40, v4
    s_nop 0
    s_cmp_ge_u32 s40, s50
    s_nop 1
    s_cbranch_scc1 Lspd_181
    s_cmp_lt_u32 s41, 131072
    s_cbranch_scc1 Lsp_180
Lspd_181:
    s_cmp_lg_u32 s3, 3
    s_cbranch_scc1 Lnoarr_182
    s_and_b32 s40, s2, 7
    s_lshl_b32 s40, s40, 5
    s_lshr_b32 s41, s2, 3
    s_add_u32 s40, s40, s41
    s_lshl_b32 s40, s40, 2
    s_add_u32 s40, s40, 2828288
    s_getreg_b32 s41, hwreg(HW_REG_XCC_ID, 0, 4)
    s_add_u32 s41, s41, 1
    v_mov_b32 v8, 0
    v_mov_b32 v9, s41
    s_mov_b64 exec, 1
    buffer_store_dword v9, v8, s[44:47], s40 offen sc1
    s_mov_b64 exec, -1
Lnoarr_182:
    v_bfe_u32 v8, v1, 2, 2
    v_lshlrev_b32 v8, 3, v8
    v_add_u32 v8, 150016, v8
    ds_read_b64 v[24:25], v8
    v_lshlrev_b32 v56, 16, v16
    v_and_b32 v57, 0xffff0000, v16
    v_lshlrev_b32 v58, 16, v17
    v_and_b32 v59, 0xffff0000, v17
    s_waitcnt lgkmcnt(0)
    v_sub_f32 v56, v56, v24
    v_sub_f32 v57, v57, v24
    v_sub_f32 v58, v58, v24
    v_sub_f32 v59, v59, v24
    v_cvt_pk_bf16_f32 v26, v56, v57
    v_lshlrev_b32 v56, 16, v26
    v_and_b32 v57, 0xffff0000, v26
    v_cvt_pk_bf16_f32 v27, v58, v59
    v_lshlrev_b32 v58, 16, v27
    v_and_b32 v59, 0xffff0000, v27
    v_mul_f32 v56, v56, v25
    v_mul_f32 v57, v57, v25
    v_mul_f32 v58, v58, v25
    v_mul_f32 v59, v59, v25
    v_cvt_pk_bf16_f32 v26, v56, v57
    v_lshlrev_b32 v56, 16, v26
    v_and_b32 v57, 0xffff0000, v26
    v_cvt_pk_bf16_f32 v27, v58, v59
    v_lshlrev_b32 v58, 16, v27
    v_and_b32 v59, 0xffff0000, v27
    v_lshrrev_b32 v15, 2, v1
    v_lshlrev_b32 v8, 8, v15
    v_and_b32 v15, 7, v15
    s_lshl_b32 s40, s3, 1
    v_xor_b32 v15, s40, v15
    v_lshl_add_u32 v8, v15, 5, v8
    v_and_b32 v15, 3, v1
    v_lshl_add_u32 v8, v15, 3, v8
    v_xor_b32 v9, 32, v8
    v_add_u32 v10, 0x10000, v8
    v_add_u32 v11, 0x10000, v9
    s_mov_b32 s41, 0
    s_nop 0
Lsp_183:
    ds_read_b32 v4, v2 offset:4
    s_add_u32 s41, s41, 1
    s_waitcnt lgkmcnt(0)
    v_readfirstlane_b32 s40, v4
    s_nop 0
    s_cmp_ge_u32 s40, 4
    s_nop 1
    s_cbranch_scc1 Lspd_184
    s_cmp_lt_u32 s41, 131072
    s_cbranch_scc1 Lsp_183
Lspd_184:
    ds_read_b64_tr_b16 v[160:161], v8 offset:16384
    ds_read_b64_tr_b16 v[162:163], v8 offset:20480
    ds_read_b64_tr_b16 v[164:165], v9 offset:16384
    ds_read_b64_tr_b16 v[166:167], v9 offset:20480
    ds_read_b64_tr_b16 v[168:169], v8 offset:49152
    ds_read_b64_tr_b16 v[170:171], v8 offset:53248
    ds_read_b64_tr_b16 v[172:173], v9 offset:49152
    ds_read_b64_tr_b16 v[174:175], v9 offset:53248
    ds_read_b64_tr_b16 v[176:177], v10 offset:16384
    ds_read_b64_tr_b16 v[178:179], v10 offset:20480
    ds_read_b64_tr_b16 v[180:181], v11 offset:16384
    ds_read_b64_tr_b16 v[182:183], v11 offset:20480
    ds_read_b64_tr_b16 v[184:185], v10 offset:49152
    ds_read_b64_tr_b16 v[186:187], v10 offset:53248
    ds_read_b64_tr_b16 v[188:189], v11 offset:49152
    ds_read_b64_tr_b16 v[190:191], v11 offset:53248
    s_waitcnt lgkmcnt(0)
    s_mov_b64 exec, 1
    ds_add_u32 v2, v3 offset:36
    s_mov_b64 exec, -1
    s_cmp_ge_u32 s99, 224
    s_cbranch_scc1 Lpl_185
    v_lshrrev_b32 v15, 2, v1
    v_lshlrev_b32 v8, 8, v15
    v_and_b32 v15, 7, v15
    s_lshl_b32 s40, s3, 1
    v_xor_b32 v15, s40, v15
    v_lshl_add_u32 v8, v15, 5, v8
    v_and_b32 v15, 3, v1
    v_lshl_add_u32 v8, v15, 3, v8
    v_xor_b32 v9, 32, v8
    v_add_u32 v10, 0x10000, v8
    v_add_u32 v11, 0x10000, v9
    s_mov_b32 s41, 0
    s_nop 0
Lsp_187:
    ds_read_b32 v4, v2 offset:16
    s_add_u32 s41, s41, 1
    s_waitcnt lgkmcnt(0)
    v_readfirstlane_b32 s40, v4
    s_nop 0
    s_cmp_ge_u32 s40, 4
    s_nop 1
    s_cbranch_scc1 Lspd_188
    s_cmp_lt_u32 s41, 131072
    s_cbranch_scc1 Lsp_187
Lspd_188:
    ds_read_b64_tr_b16 v[64:65], v8 offset:24576
    ds_read_b64_tr_b16 v[66:67], v8 offset:28672
    ds_read_b64_tr_b16 v[68:69], v9 offset:24576
    ds_read_b64_tr_b16 v[70:71], v9 offset:28672
    ds_read_b64_tr_b16 v[72:73], v8 offset:57344
    ds_read_b64_tr_b16 v[74:75], v8 offset:61440
    ds_read_b64_tr_b16 v[76:77], v9 offset:57344
    ds_read_b64_tr_b16 v[78:79], v9 offset:61440
    ds_read_b64_tr_b16 v[80:81], v10 offset:24576
    ds_read_b64_tr_b16 v[82:83], v10 offset:28672
    ds_read_b64_tr_b16 v[84:85], v11 offset:24576
    ds_read_b64_tr_b16 v[86:87], v11 offset:28672
    ds_read_b64_tr_b16 v[88:89], v10 offset:57344
    ds_read_b64_tr_b16 v[90:91], v10 offset:61440
    ds_read_b64_tr_b16 v[92:93], v11 offset:57344
    ds_read_b64_tr_b16 v[94:95], v11 offset:61440
    s_waitcnt lgkmcnt(0)
    s_mov_b64 exec, 1
    ds_add_u32 v2, v3 offset:48
    s_mov_b64 exec, -1
    s_branch Lpld_186
Lpl_185:
    s_mov_b64 exec, 1
    ds_add_u32 v2, v3 offset:48
    s_mov_b64 exec, -1
Lpld_186:
    s_cmp_eq_u32 s0, 0
    s_cbranch_scc1 Lpl_189
    v_lshrrev_b32 v15, 2, v1
    v_lshlrev_b32 v8, 8, v15
    v_and_b32 v15, 7, v15
    v_lshl_add_u32 v8, v15, 5, v8
    v_and_b32 v15, 3, v1
    v_lshl_add_u32 v8, v15, 3, v8
    v_add_u32 v8, s32, v8
    v_xor_b32 v9, 32, v8
    v_xor_b32 v10, 64, v8
    v_xor_b32 v11, 96, v8
    v_xor_b32 v12, 128, v8
    v_xor_b32 v13, 160, v8
    v_xor_b32 v14, 192, v8
    v_xor_b32 v15, 224, v8
    s_mov_b32 s41, 0
    s_nop 0
Lsp_191:
    ds_read_b32 v4, v2 offset:20
    s_add_u32 s41, s41, 1
    s_waitcnt lgkmcnt(0)
    v_readfirstlane_b32 s40, v4
    s_nop 0
    s_cmp_ge_u32 s40, 4
    s_nop 1
    s_cbranch_scc1 Lspd_192
    s_cmp_lt_u32 s41, 131072
    s_cbranch_scc1 Lsp_191
Lspd_192:
    ds_read_b64_tr_b16 v[192:193], v8 offset:0
    ds_read_b64_tr_b16 v[194:195], v8 offset:4096
    ds_read_b64_tr_b16 v[196:197], v9 offset:0
    ds_read_b64_tr_b16 v[198:199], v9 offset:4096
    ds_read_b64_tr_b16 v[200:201], v10 offset:0
    ds_read_b64_tr_b16 v[202:203], v10 offset:4096
    ds_read_b64_tr_b16 v[204:205], v11 offset:0
    ds_read_b64_tr_b16 v[206:207], v11 offset:4096
    ds_read_b64_tr_b16 v[208:209], v12 offset:0
    ds_read_b64_tr_b16 v[210:211], v12 offset:4096
    ds_read_b64_tr_b16 v[212:213], v13 offset:0
    ds_read_b64_tr_b16 v[214:215], v13 offset:4096
    ds_read_b64_tr_b16 v[216:217], v14 offset:0
    ds_read_b64_tr_b16 v[218:219], v14 offset:4096
    ds_read_b64_tr_b16 v[220:221], v15 offset:0
    ds_read_b64_tr_b16 v[222:223], v15 offset:4096
    s_waitcnt lgkmcnt(0)
    s_mov_b64 exec, 1
    ds_add_u32 v2, v3 offset:52
    s_mov_b64 exec, -1
    s_branch Lpld_190
Lpl_189:
    s_mov_b64 exec, 1
    ds_add_u32 v2, v3 offset:52
    s_mov_b64 exec, -1
Lpld_190:
    s_cmp_ge_u32 s99, 224
    s_cbranch_scc1 Lpl_193
    v_lshrrev_b32 v15, 2, v1
    v_lshlrev_b32 v8, 8, v15
    v_and_b32 v15, 7, v15
    s_lshl_b32 s40, s3, 1
    v_xor_b32 v15, s40, v15
    v_lshl_add_u32 v8, v15, 5, v8
    v_and_b32 v15, 3, v1
    v_lshl_add_u32 v8, v15, 3, v8
    v_xor_b32 v9, 32, v8
    v_add_u32 v10, 0x10000, v8
    v_add_u32 v11, 0x10000, v9
    s_mov_b32 s41, 0
    s_nop 0
Lsp_195:
    ds_read_b32 v4, v2 offset:8
    s_add_u32 s41, s41, 1
    s_waitcnt lgkmcnt(0)
    v_readfirstlane_b32 s40, v4
    s_nop 0
    s_cmp_ge_u32 s40, 4
    s_nop 1
    s_cbranch_scc1 Lspd_196
    s_cmp_lt_u32 s41, 131072
    s_cbranch_scc1 Lsp_195
Lspd_196:
    ds_read_b64_tr_b16 v[96:97], v8 offset:8192
    ds_read_b64_tr_b16 v[98:99], v8 offset:12288
    ds_read_b64_tr_b16 v[100:101], v9 offset:8192
    ds_read_b64_tr_b16 v[102:103], v9 offset:12288
    ds_read_b64_tr_b16 v[104:105], v8 offset:40960
    ds_read_b64_tr_b16 v[106:107], v8 offset:45056
    ds_read_b64_tr_b16 v[108:109], v9 offset:40960
    ds_read_b64_tr_b16 v[110:111], v9 offset:45056
    ds_read_b64_tr_b16 v[112:113], v10 offset:8192
    ds_read_b64_tr_b16 v[114:115], v10 offset:12288
    ds_read_b64_tr_b16 v[116:117], v11 offset:8192
    ds_read_b64_tr_b16 v[118:119], v11 offset:12288
    ds_read_b64_tr_b16 v[120:121], v10 offset:40960
    ds_read_b64_tr_b16 v[122:123], v10 offset:45056
    ds_read_b64_tr_b16 v[124:125], v11 offset:40960
    ds_read_b64_tr_b16 v[126:127], v11 offset:45056
    s_waitcnt lgkmcnt(0)
    s_mov_b64 exec, 1
    ds_add_u32 v2, v3 offset:40
    s_mov_b64 exec, -1
    s_branch Lpld_194
Lpl_193:
    v_lshrrev_b32 v15, 2, v1
    v_lshlrev_b32 v8, 8, v15
    v_and_b32 v15, 7, v15
    v_lshl_add_u32 v8, v15, 5, v8
    v_and_b32 v15, 3, v1
    v_lshl_add_u32 v8, v15, 3, v8
    v_add_u32 v8, s32, v8
    v_xor_b32 v9, 32, v8
    v_xor_b32 v10, 64, v8
    v_xor_b32 v11, 96, v8
    v_xor_b32 v12, 128, v8
    v_xor_b32 v13, 160, v8
    v_xor_b32 v14, 192, v8
    v_xor_b32 v15, 224, v8
    s_mov_b32 s41, 0
    s_nop 0
Lsp_197:
    ds_read_b32 v4, v2 offset:8
    s_add_u32 s41, s41, 1
    s_waitcnt lgkmcnt(0)
    v_readfirstlane_b32 s40, v4
    s_nop 0
    s_cmp_ge_u32 s40, 4
    s_nop 1
    s_cbranch_scc1 Lspd_198
    s_cmp_lt_u32 s41, 131072
    s_cbranch_scc1 Lsp_197
Lspd_198:
    ds_read_b64_tr_b16 v[96:97], v8 offset:8192
    ds_read_b64_tr_b16 v[98:99], v8 offset:12288
    ds_read_b64_tr_b16 v[100:101], v9 offset:8192
    ds_read_b64_tr_b16 v[102:103], v9 offset:12288
    ds_read_b64_tr_b16 v[104:105], v10 offset:8192
    ds_read_b64_tr_b16 v[106:107], v10 offset:12288
    ds_read_b64_tr_b16 v[108:109], v11 offset:8192
    ds_read_b64_tr_b16 v[110:111], v11 offset:12288
    ds_read_b64_tr_b16 v[112:113], v12 offset:8192
    ds_read_b64_tr_b16 v[114:115], v12 offset:12288
    ds_read_b64_tr_b16 v[116:117], v13 offset:8192
    ds_read_b64_tr_b16 v[118:119], v13 offset:12288
    ds_read_b64_tr_b16 v[120:121], v14 offset:8192
    ds_read_b64_tr_b16 v[122:123], v14 offset:12288
    ds_read_b64_tr_b16 v[124:125], v15 offset:8192
    ds_read_b64_tr_b16 v[126:127], v15 offset:12288
    s_waitcnt lgkmcnt(0)
    s_mov_b64 exec, 1
    ds_add_u32 v2, v3 offset:40
    s_mov_b64 exec, -1
Lpld_194:
    s_cmp_ge_u32 s99, 224
    s_cbranch_scc1 Lpl_199
    v_lshrrev_b32 v15, 2, v1
    v_lshlrev_b32 v8, 8, v15
    v_and_b32 v15, 7, v15
    s_lshl_b32 s40, s3, 1
    v_xor_b32 v15, s40, v15
    v_lshl_add_u32 v8, v15, 5, v8
    v_and_b32 v15, 3, v1
    v_lshl_add_u32 v8, v15, 3, v8
    v_xor_b32 v9, 32, v8
    v_add_u32 v10, 0x10000, v8
    v_add_u32 v11, 0x10000, v9
    s_mov_b32 s41, 0
    s_nop 0
Lsp_201:
    ds_read_b32 v4, v2 offset:12
    s_add_u32 s41, s41, 1
    s_waitcnt lgkmcnt(0)
    v_readfirstlane_b32 s40, v4
    s_nop 0
    s_cmp_ge_u32 s40, 4
    s_nop 1
    s_cbranch_scc1 Lspd_202
    s_cmp_lt_u32 s41, 131072
    s_cbranch_scc1 Lsp_201
Lspd_202:
    ds_read_b64_tr_b16 v[128:129], v8 offset:16384
    ds_read_b64_tr_b16 v[130:131], v8 offset:20480
    ds_read_b64_tr_b16 v[132:133], v9 offset:16384
    ds_read_b64_tr_b16 v[134:135], v9 offset:20480
    ds_read_b64_tr_b16 v[136:137], v8 offset:49152
    ds_read_b64_tr_b16 v[138:139], v8 offset:53248
    ds_read_b64_tr_b16 v[140:141], v9 offset:49152
    ds_read_b64_tr_b16 v[142:143], v9 offset:53248
    ds_read_b64_tr_b16 v[144:145], v10 offset:16384
    ds_read_b64_tr_b16 v[146:147], v10 offset:20480
    ds_read_b64_tr_b16 v[148:149], v11 offset:16384
    ds_read_b64_tr_b16 v[150:151], v11 offset:20480
    ds_read_b64_tr_b16 v[152:153], v10 offset:49152
    ds_read_b64_tr_b16 v[154:155], v10 offset:53248
    ds_read_b64_tr_b16 v[156:157], v11 offset:49152
    ds_read_b64_tr_b16 v[158:159], v11 offset:53248
    s_waitcnt lgkmcnt(0)
    s_mov_b64 exec, 1
    ds_add_u32 v2, v3 offset:44
    s_mov_b64 exec, -1
    s_branch Lpld_200
Lpl_199:
    v_lshrrev_b32 v15, 2, v1
    v_lshlrev_b32 v8, 8, v15
    v_and_b32 v15, 7, v15
    v_lshl_add_u32 v8, v15, 5, v8
    v_and_b32 v15, 3, v1
    v_lshl_add_u32 v8, v15, 3, v8
    v_add_u32 v8, s32, v8
    v_xor_b32 v9, 32, v8
    v_xor_b32 v10, 64, v8
    v_xor_b32 v11, 96, v8
    v_xor_b32 v12, 128, v8
    v_xor_b32 v13, 160, v8
    v_xor_b32 v14, 192, v8
    v_xor_b32 v15, 224, v8
    s_mov_b32 s41, 0
    s_nop 0
Lsp_203:
    ds_read_b32 v4, v2 offset:12
    s_add_u32 s41, s41, 1
    s_waitcnt lgkmcnt(0)
    v_readfirstlane_b32 s40, v4
    s_nop 0
    s_cmp_ge_u32 s40, 4
    s_nop 1
    s_cbranch_scc1 Lspd_204
    s_cmp_lt_u32 s41, 131072
    s_cbranch_scc1 Lsp_203
Lspd_204:
    ds_read_b64_tr_b16 v[128:129], v8 offset:16384
    ds_read_b64_tr_b16 v[130:131], v8 offset:20480
    ds_read_b64_tr_b16 v[132:133], v9 offset:16384
    ds_read_b64_tr_b16 v[134:135], v9 offset:20480
    ds_read_b64_tr_b16 v[136:137], v10 offset:16384
    ds_read_b64_tr_b16 v[138:139], v10 offset:20480
    ds_read_b64_tr_b16 v[140:141], v11 offset:16384
    ds_read_b64_tr_b16 v[142:143], v11 offset:20480
    ds_read_b64_tr_b16 v[144:145], v12 offset:16384
    ds_read_b64_tr_b16 v[146:147], v12 offset:20480
    ds_read_b64_tr_b16 v[148:149], v13 offset:16384
    ds_read_b64_tr_b16 v[150:151], v13 offset:20480
    ds_read_b64_tr_b16 v[152:153], v14 offset:16384
    ds_read_b64_tr_b16 v[154:155], v14 offset:20480
    ds_read_b64_tr_b16 v[156:157], v15 offset:16384
    ds_read_b64_tr_b16 v[158:159], v15 offset:20480
    s_waitcnt lgkmcnt(0)
    s_mov_b64 exec, 1
    ds_add_u32 v2, v3 offset:44
    s_mov_b64 exec, -1
Lpld_200:
    s_cmp_lg_u32 s3, 0
    s_cbranch_scc1 Lgb1_205
    s_mov_b32 s40, 2828288
    s_mov_b32 s41, 0
Lg_206:
    buffer_load_dwordx4 v[24:27], v5, s[44:47], s40 offen offset:0 sc1
    s_waitcnt vmcnt(0)
    v_max3_u32 v4, v24, v25, v26
    v_max_u32 v4, v4, v27
    v_cmp_eq_u32 vcc, -1, v4
    s_add_u32 s41, s41, 1
    s_cbranch_vccz Lgd_207
    s_mov_b64 exec, vcc
    s_sleep 8
    s_cmp_lt_u32 s41, 8192
    s_cbranch_scc1 Lg_206
Lgd_207:
    s_mov_b64 exec, -1
    v_xor_b32 v25, v25, v24
    v_xor_b32 v26, v26, v24
    v_xor_b32 v27, v27, v24
    v_or3_b32 v25, v25, v26, v27
    v_mov_b32_dpp v26, v24 row_ror:1 row_mask:0xf bank_mask:0xf
    v_xor_b32 v26, v26, v24
    v_and_b32 v27, 7, v1
    v_cmp_eq_u32 vcc, 0, v27
    s_nop 1
    v_cndmask_b32 v26, v26, 0, vcc
    v_or_b32 v25, v25, v26
    v_cmp_ne_u32 vcc, 0, v25
    s_nop 0
    s_cbranch_vccnz Lgb1_205
    s_mov_b64 exec, 1
    ds_add_u32 v2, v3 offset:108
    s_mov_b64 exec, -1
Lgb1_205:
    s_add_u32 s50, s50, 4
    s_waitcnt lgkmcnt(0)
    s_mov_b64 exec, 1
    ds_add_u32 v2, v3 offset:76
    s_mov_b64 exec, -1
    s_mov_b32 s41, 0
Lsp_208:
    ds_read_b32 v4, v2 offset:76
    s_add_u32 s41, s41, 1
    s_waitcnt lgkmcnt(0)
    v_readfirstlane_b32 s40, v4
    s_nop 0
    s_cmp_ge_u32 s40, s50
    s_nop 1
    s_cbranch_scc1 Lspd_209
    s_cmp_lt_u32 s41, 131072
    s_cbranch_scc1 Lsp_208
Lspd_209:
    s_mov_b32 s41, 0
Lsp_210:
    ds_read_b32 v4, v2 offset:96
    s_add_u32 s41, s41, 1
    s_waitcnt lgkmcnt(0)
    v_readfirstlane_b32 s40, v4
    s_nop 0
    s_cmp_ge_u32 s40, 4
    s_nop 1
    s_cbranch_scc1 Lspd_211
    s_cmp_lt_u32 s41, 131072
    s_cbranch_scc1 Lsp_210
Lspd_211:
    v_bfe_u32 v13, v1, 2, 2
    v_and_b32 v14, 3, v1
    v_lshrrev_b32 v15, 4, v1
    v_mul_u32_u24 v8, 8320, v13
    v_mul_u32_u24 v14, 16, v14
    v_mul_u32_u24 v15, 64, v15
    v_add3_u32 v8, v8, v14, v15
    s_lshl_b32 s40, s36, 10
    s_lshl_b32 s41, s3, 8
    s_add_u32 s40, s40, s41
    s_add_u32 s52, s40, 2686976
    s_add_u32 s53, s52, 33280
    s_add_u32 s54, s52, 66560
    s_add_u32 s55, s52, 99840
    s_add_u32 s56, s52, 4096
    s_add_u32 s57, s52, 37376
    s_add_u32 s58, s52, 70656
    s_add_u32 s59, s52, 103936
    s_mov_b32 s41, 0
Lg_212:
    buffer_load_dwordx4 v[16:19], v8, s[44:47], s52 offen offset:0 sc1
    buffer_load_dwordx4 v[20:23], v8, s[44:47], s53 offen offset:0 sc1
    buffer_load_dwordx4 v[24:27], v8, s[44:47], s54 offen offset:0 sc1
    buffer_load_dwordx4 v[28:31], v8, s[44:47], s55 offen offset:0 sc1
    buffer_load_dwordx4 v[32:35], v8, s[44:47], s56 offen offset:0 sc1
    buffer_load_dwordx4 v[36:39], v8, s[44:47], s57 offen offset:0 sc1
    buffer_load_dwordx4 v[40:43], v8, s[44:47], s58 offen offset:0 sc1
    buffer_load_dwordx4 v[44:47], v8, s[44:47], s59 offen offset:0 sc1
    s_waitcnt vmcnt(0)
    v_max3_u32 v4, v16, v17, v18
    v_max3_u32 v4, v4, v19, v20
    v_max3_u32 v4, v4, v21, v22
    v_max3_u32 v4, v4, v23, v24
    v_max3_u32 v4, v4, v25, v26
    v_max3_u32 v4, v4, v27, v28
    v_max3_u32 v4, v4, v29, v30
    v_max3_u32 v4, v4, v31, v32
    v_max3_u32 v4, v4, v33, v34
    v_max3_u32 v4, v4, v35, v36
    v_max3_u32 v4, v4, v37, v38
    v_max3_u32 v4, v4, v39, v40
    v_max3_u32 v4, v4, v41, v42
    v_max3_u32 v4, v4, v43, v44
    v_max3_u32 v4, v4, v45, v46
    v_max_u32 v4, v4, v47
    v_cmp_eq_u32 vcc, -1, v4
    s_add_u32 s41, s41, 1
    s_cbranch_vccz Lgd_213
    s_mov_b64 exec, vcc
    s_sleep 8
    s_cmp_lt_u32 s41, 8192
    s_cbranch_scc1 Lg_212
Lgd_213:
    s_mov_b64 exec, -1
    v_pk_add_f32 v[16:17], v[16:17], v[20:21]
    v_pk_add_f32 v[24:25], v[24:25], v[28:29]
    v_pk_add_f32 v[48:49], v[16:17], v[24:25]
    v_pk_add_f32 v[18:19], v[18:19], v[22:23]
    v_pk_add_f32 v[26:27], v[26:27], v[30:31]
    v_pk_add_f32 v[50:51], v[18:19], v[26:27]
    v_pk_add_f32 v[32:33], v[32:33], v[36:37]
    v_pk_add_f32 v[40:41], v[40:41], v[44:45]
    v_pk_add_f32 v[52:53], v[32:33], v[40:41]
    v_pk_add_f32 v[34:35], v[34:35], v[38:39]
    v_pk_add_f32 v[42:43], v[42:43], v[46:47]
    v_pk_add_f32 v[54:55], v[34:35], v[42:43]
    v_cvt_pk_bf16_f32 v8, v48, v49
    v_lshlrev_b32 v48, 16, v8
    v_and_b32 v49, 0xffff0000, v8
    v_cvt_pk_bf16_f32 v9, v50, v51
    v_lshlrev_b32 v50, 16, v9
    v_and_b32 v51, 0xffff0000, v9
    v_cvt_pk_bf16_f32 v8, v52, v53
    v_lshlrev_b32 v52, 16, v8
    v_and_b32 v53, 0xffff0000, v8
    v_cvt_pk_bf16_f32 v9, v54, v55
    v_lshlrev_b32 v54, 16, v9
    v_and_b32 v55, 0xffff0000, v9
    v_add_f32 v52, 1.0, v52
    v_add_f32 v53, 1.0, v53
    v_add_f32 v54, 1.0, v54
    v_add_f32 v55, 1.0, v55
    v_cvt_pk_bf16_f32 v8, v52, v53
    v_lshlrev_b32 v52, 16, v8
    v_and_b32 v53, 0xffff0000, v8
    v_cvt_pk_bf16_f32 v9, v54, v55
    v_lshlrev_b32 v54, 16, v9
    v_and_b32 v55, 0xffff0000, v9
    v_mul_f32 v56, v56, v52
    v_mul_f32 v57, v57, v53
    v_mul_f32 v58, v58, v54
    v_mul_f32 v59, v59, v55
    v_cvt_pk_bf16_f32 v8, v56, v57
    v_lshlrev_b32 v56, 16, v8
    v_and_b32 v57, 0xffff0000, v8
    v_cvt_pk_bf16_f32 v9, v58, v59
    v_lshlrev_b32 v58, 16, v9
    v_and_b32 v59, 0xffff0000, v9
    v_add_f32 v56, v56, v48
    v_add_f32 v57, v57, v49
    v_add_f32 v58, v58, v50
    v_add_f32 v59, v59, v51
    v_cvt_pk_bf16_f32 v24, v56, v57
    v_cvt_pk_bf16_f32 v25, v58, v59
    v_mov_b32 v16, v24
    v_mov_b32 v20, v25
    s_nop 0
    v_mov_b32_dpp v17, v16 quad_perm:[1,1,1,1] row_mask:0xf bank_mask:0xf
    v_mov_b32_dpp v18, v16 quad_perm:[2,2,2,2] row_mask:0xf bank_mask:0xf
    v_mov_b32_dpp v19, v16 quad_perm:[3,3,3,3] row_mask:0xf bank_mask:0xf
    v_mov_b32_dpp v16, v16 quad_perm:[0,0,0,0] row_mask:0xf bank_mask:0xf
    v_mov_b32_dpp v21, v20 quad_perm:[1,1,1,1] row_mask:0xf bank_mask:0xf
    v_mov_b32_dpp v22, v20 quad_perm:[2,2,2,2] row_mask:0xf bank_mask:0xf
    v_mov_b32_dpp v23, v20 quad_perm:[3,3,3,3] row_mask:0xf bank_mask:0xf
    v_mov_b32_dpp v20, v20 quad_perm:[0,0,0,0] row_mask:0xf bank_mask:0xf
    v_mfma_f32_16x16x32_bf16 v[24:27], v[16:19], v[192:195], 0
    v_mfma_f32_16x16x32_bf16 v[28:31], v[16:19], v[196:199], 0
    v_mfma_f32_16x16x32_bf16 v[32:35], v[16:19], v[200:203], 0
    v_mfma_f32_16x16x32_bf16 v[36:39], v[16:19], v[204:207], 0
    v_mfma_f32_16x16x32_bf16 v[40:43], v[16:19], v[208:211], 0
    v_mfma_f32_16x16x32_bf16 v[44:47], v[16:19], v[212:215], 0
    v_mfma_f32_16x16x32_bf16 v[48:51], v[16:19], v[216:219], 0
    v_mfma_f32_16x16x32_bf16 v[52:55], v[16:19], v[220:223], 0
    v_mfma_f32_16x16x32_bf16 v[24:27], v[20:23], v[224:227], v[24:27]
    v_mfma_f32_16x16x32_bf16 v[28:31], v[20:23], v[228:231], v[28:31]
    v_mfma_f32_16x16x32_bf16 v[32:35], v[20:23], v[232:235], v[32:35]
    v_mfma_f32_16x16x32_bf16 v[36:39], v[20:23], v[236:239], v[36:39]
    v_mfma_f32_16x16x32_bf16 v[40:43], v[20:23], v[240:243], v[40:43]
    v_mfma_f32_16x16x32_bf16 v[44:47], v[20:23], v[244:247], v[44:47]
    v_mfma_f32_16x16x32_bf16 v[48:51], v[20:23], v[248:251], v[48:51]
    v_mfma_f32_16x16x32_bf16 v[52:55], v[20:23], v[252:255], v[52:55]
    s_nop 0
    ds_write_b32 v6, v24 offset:0
    ds_write_b32 v6, v28 offset:64
    ds_write_b32 v6, v32 offset:128
    ds_write_b32 v6, v36 offset:192
    ds_write_b32 v6, v40 offset:256
    ds_write_b32 v6, v44 offset:320
    ds_write_b32 v6, v48 offset:384
    ds_write_b32 v6, v52 offset:448
    s_add_u32 s50, s50, 4
    s_waitcnt lgkmcnt(0)
    s_mov_b64 exec, 1
    ds_add_u32 v2, v3 offset:76
    s_mov_b64 exec, -1
    s_mov_b32 s41, 0
Lsp_214:
    ds_read_b32 v4, v2 offset:76
    s_add_u32 s41, s41, 1
    s_waitcnt lgkmcnt(0)
    v_readfirstlane_b32 s40, v4
    s_nop 0
    s_cmp_ge_u32 s40, s50
    s_nop 1
    s_cbranch_scc1 Lspd_215
    s_cmp_lt_u32 s41, 131072
    s_cbranch_scc1 Lsp_214
Lspd_215:
    s_cmp_ge_u32 s3, 2
    s_cbranch_scc1 Lnosum_216
    ds_read_b128 v[24:27], v7 offset:0
    ds_read_b128 v[28:31], v7 offset:2304
    ds_read_b128 v[32:35], v7 offset:4608
    ds_read_b128 v[36:39], v7 offset:6912
    s_waitcnt lgkmcnt(0)
    v_pk_add_f32 v[24:25], v[24:25], v[28:29]
    v_pk_add_f32 v[26:27], v[26:27], v[30:31]
    v_pk_add_f32 v[32:33], v[32:33], v[36:37]
    v_pk_add_f32 v[34:35], v[34:35], v[38:39]
    v_pk_add_f32 v[24:25], v[24:25], v[32:33]
    v_pk_add_f32 v[26:27], v[26:27], v[34:35]
    v_min_u32 v24, -2, v24
    v_min_u32 v25, -2, v25
    v_min_u32 v26, -2, v26
    v_min_u32 v27, -2, v27
    s_nop 1
Lnosum_216:
    s_cmp_ge_u32 s3, 2
    s_cbranch_scc1 Lnopub_217
    s_lshl_b32 s40, s36, 1
    s_add_u32 s40, s40, s3
    s_mul_i32 s40, s40, 33024
    s_lshl_b32 s41, s39, 9
    s_add_u32 s40, s40, s41
    s_add_u32 s40, s40, 2398208
    v_lshrrev_b32 v8, 5, v1
    v_mul_u32_u24 v8, 16512, v8
    v_and_b32 v9, 31, v1
    v_lshl_add_u32 v8, v9, 4, v8
    buffer_store_dwordx4 v[24:27], v8, s[44:47], s40 offen sc1
    s_nop 1
Lnopub_217:
L_common:
    s_mov_b32 s41, 0
Lsp_218:
    ds_read_b32 v4, v2 offset:88
    s_add_u32 s41, s41, 1
    s_waitcnt lgkmcnt(0)
    v_readfirstlane_b32 s40, v4
    s_nop 0
    s_cmp_ge_u32 s40, 4
    s_nop 1
    s_cbranch_scc1 Lspd_219
    s_cmp_lt_u32 s41, 131072
    s_cbranch_scc1 Lsp_218
Lspd_219:
    s_lshr_b32 s40, s37, 2
    s_mul_i32 s40, s40, 16512
    s_and_b32 s41, s37, 3
    s_lshl_b32 s41, s41, 12
    s_add_u32 s40, s40, s41
    s_lshl_b32 s41, s3, 10
    s_add_u32 s40, s40, s41
    s_add_u32 s52, s40, 2398208
    s_add_u32 s53, s52, 66048
    s_add_u32 s54, s52, 132096
    s_add_u32 s55, s52, 198144
    s_mov_b32 s41, 0
Lg_220:
    buffer_load_dwordx4 v[24:27], v5, s[44:47], s52 offen offset:0 sc1
    buffer_load_dwordx4 v[28:31], v5, s[44:47], s53 offen offset:0 sc1
    buffer_load_dwordx4 v[32:35], v5, s[44:47], s54 offen offset:0 sc1
    buffer_load_dwordx4 v[36:39], v5, s[44:47], s55 offen offset:0 sc1
    s_waitcnt vmcnt(0)
    v_max3_u32 v4, v24, v25, v26
    v_max3_u32 v4, v4, v27, v28
    v_max3_u32 v4, v4, v29, v30
    v_max3_u32 v4, v4, v31, v32
    v_max3_u32 v4, v4, v33, v34
    v_max3_u32 v4, v4, v35, v36
    v_max3_u32 v4, v4, v37, v38
    v_max_u32 v4, v4, v39
    v_cmp_eq_u32 vcc, -1, v4
    s_add_u32 s41, s41, 1
    s_cbranch_vccz Lgd_221
    s_mov_b64 exec, vcc
    s_sleep 12
    s_cmp_lt_u32 s41, 8192
    s_cbranch_scc1 Lg_220
Lgd_221:
    s_mov_b64 exec, -1
    s_mov_b32 s42, s41
    v_pk_add_f32 v[24:25], v[24:25], v[28:29]
    v_pk_add_f32 v[26:27], v[26:27], v[30:31]
    v_pk_add_f32 v[32:33], v[32:33], v[36:37]
    v_pk_add_f32 v[34:35], v[34:35], v[38:39]
    v_pk_add_f32 v[24:25], v[24:25], v[32:33]
    v_pk_add_f32 v[26:27], v[26:27], v[34:35]
    s_mul_i32 s40, s3, 544
    s_add_u32 s40, s40, 147456
    v_lshrrev_b32 v8, 5, v1
    v_mul_u32_u24 v8, 272, v8
    v_and_b32 v9, 31, v1
    v_lshl_add_u32 v8, v9, 3, v8
    v_add_u32 v8, s40, v8
    v_cvt_pk_bf16_f32 v24, v24, v25
    v_cvt_pk_bf16_f32 v25, v26, v27
    ds_write_b64 v8, v[24:25]
    s_waitcnt lgkmcnt(0)
    s_mov_b64 exec, 1
    ds_add_u32 v2, v3 offset:64
    s_mov_b64 exec, -1
    s_add_u32 s50, s50, 4
    s_waitcnt lgkmcnt(0)
    s_mov_b64 exec, 1
    ds_add_u32 v2, v3 offset:76
    s_mov_b64 exec, -1
    s_mov_b32 s41, 0
Lsp_222:
    ds_read_b32 v4, v2 offset:76
    s_add_u32 s41, s41, 1
    s_waitcnt lgkmcnt(0)
    v_readfirstlane_b32 s40, v4
    s_nop 0
    s_cmp_ge_u32 s40, s50
    s_nop 1
    s_cbranch_scc1 Lspd_223
    s_cmp_lt_u32 s41, 131072
    s_cbranch_scc1 Lsp_222
Lspd_223:
    s_cmp_eq_u32 s0, 0
    s_cbranch_scc1 Lnog_224
    v_mfma_f32_16x16x32_bf16 v[24:27], v[56:59], v[192:195], 0
    v_mfma_f32_16x16x32_bf16 v[28:31], v[56:59], v[196:199], 0
    v_mfma_f32_16x16x32_bf16 v[32:35], v[56:59], v[200:203], 0
    v_mfma_f32_16x16x32_bf16 v[36:39], v[56:59], v[204:207], 0
    v_mfma_f32_16x16x32_bf16 v[40:43], v[56:59], v[208:211], 0
    v_mfma_f32_16x16x32_bf16 v[44:47], v[56:59], v[212:215], 0
    v_mfma_f32_16x16x32_bf16 v[48:51], v[56:59], v[216:219], 0
    v_mfma_f32_16x16x32_bf16 v[52:55], v[56:59], v[220:223], 0
    s_nop 0
    ds_write_b32 v6, v24 offset:0
    ds_write_b32 v6, v28 offset:64
    ds_write_b32 v6, v32 offset:128
    ds_write_b32 v6, v36 offset:192
    ds_write_b32 v6, v40 offset:256
    ds_write_b32 v6, v44 offset:320
    ds_write_b32 v6, v48 offset:384
    ds_write_b32 v6, v52 offset:448
Lnog_224:
    s_mov_b32 s34, s36
    ds_read_b32 v4, v2 offset:108
    s_waitcnt lgkmcnt(0)
    v_readfirstlane_b32 s36, v4
    s_mov_b32 s41, 0
    s_nop 3
Lsp_225:
    ds_read_b32 v4, v2 offset:68
    s_add_u32 s41, s41, 1
    s_waitcnt lgkmcnt(0)
    v_readfirstlane_b32 s40, v4
    s_nop 0
    s_cmp_ge_u32 s40, 4
    s_nop 1
    s_cbranch_scc1 Lspd_226
    s_cmp_lt_u32 s41, 131072
    s_cbranch_scc1 Lsp_225
Lspd_226:
    s_cmp_lg_u32 s3, 0
    s_cbranch_scc1 Lnoml_227
    v_and_b32 v8, 7, v1
    v_lshlrev_b32 v9, 3, v8
    v_add_u32 v8, 149760, v9
    ds_read_b64 v[16:17], v8
    ds_read_b64 v[18:19], v8 offset:64
    ds_read_b64 v[20:21], v8 offset:128
    ds_read_b64 v[22:23], v8 offset:192
    s_lshl_b32 s40, s37, 10
    s_lshl_b32 s41, s38, 6
    s_add_u32 s40, s40, s41
    s_add_u32 s40, s40, 2353152
    s_waitcnt lgkmcnt(0)
    v_max3_f32 v24, v16, v18, v20
    v_max_f32 v24, v24, v22
    v_sub_f32 v16, v16, v24
    v_sub_f32 v18, v18, v24
    v_sub_f32 v20, v20, v24
    v_sub_f32 v22, v22, v24
    v_exp_f32 v16, v16
    v_exp_f32 v18, v18
    v_exp_f32 v20, v20
    v_exp_f32 v22, v22
    v_mul_f32 v25, v16, v17
    v_fmac_f32 v25, v18, v19
    v_fmac_f32 v25, v20, v21
    v_fmac_f32 v25, v22, v23
    v_min_u32 v24, -2, v24
    v_min_u32 v25, -2, v25
    s_mov_b64 exec, 0xff
    s_cmp_lg_u32 s36, 0
    s_cbranch_scc1 Lnoml_227_l
    buffer_store_dwordx2 v[24:25], v9, s[44:47], s40 offen sc1
    s_branch Lnoml_227_d
Lnoml_227_l:
    buffer_store_dwordx2 v[24:25], v9, s[44:47], s40 offen
Lnoml_227_d:
    s_mov_b64 exec, -1
Lnoml_227:
    v_bfe_u32 v13, v1, 2, 2
    v_and_b32 v14, 3, v1
    v_lshrrev_b32 v15, 4, v1
    v_mul_u32_u24 v50, 2176, v13
    v_mul_u32_u24 v14, 16, v14
    v_mul_u32_u24 v15, 139264, v15
    v_add3_u32 v50, v50, v14, v15
    v_bfe_u32 v13, v1, 2, 2
    v_and_b32 v14, 3, v1
    v_lshrrev_b32 v15, 4, v1
    v_mul_u32_u24 v55, 8, v13
    v_mul_u32_u24 v14, 32, v14
    v_mul_u32_u24 v15, 14464, v15
    v_add3_u32 v55, v55, v14, v15
    v_bfe_u32 v13, v1, 2, 2
    v_and_b32 v14, 3, v1
    v_lshrrev_b32 v15, 4, v1
    v_mul_u32_u24 v57, 4, v13
    v_mul_u32_u24 v14, 16, v14
    v_mul_u32_u24 v15, 2048, v15
    v_add3_u32 v57, v57, v14, v15
    v_bfe_u32 v13, v1, 2, 2
    v_and_b32 v14, 3, v1
    v_lshrrev_b32 v15, 4, v1
    v_mul_u32_u24 v53, 16, v13
    v_mul_u32_u24 v14, 4, v14
    v_mul_u32_u24 v15, 133120, v15
    v_add3_u32 v53, v53, v14, v15
    v_bfe_u32 v13, v1, 2, 2
    v_and_b32 v14, 3, v1
    v_lshrrev_b32 v15, 4, v1
    v_mul_u32_u24 v56, 16, v13
    v_mul_u32_u24 v14, 4, v14
    v_mul_u32_u24 v15, 116736, v15
    v_add3_u32 v56, v56, v14, v15
    v_bfe_u32 v13, v1, 2, 2
    v_and_b32 v14, 3, v1
    v_lshrrev_b32 v15, 4, v1
    v_mul_u32_u24 v51, 16, v13
    v_mul_u32_u24 v14, 4, v14
    v_mul_u32_u24 v15, 14464, v15
    v_add3_u32 v51, v51, v14, v15
    v_bfe_u32 v13, v1, 2, 2
    v_and_b32 v14, 3, v1
    v_lshrrev_b32 v15, 4, v1
    v_mul_u32_u24 v52, 320, v13
    v_mul_u32_u24 v14, 0, v14
    v_mul_u32_u24 v15, 16, v15
    v_add3_u32 v52, v52, v14, v15
    v_bfe_u32 v13, v1, 2, 2
    v_and_b32 v14, 3, v1
    v_lshrrev_b32 v15, 4, v1
    v_mul_u32_u24 v60, 4, v13
    v_mul_u32_u24 v14, 16, v14
    v_mul_u32_u24 v15, 320, v15
    v_add3_u32 v60, v60, v14, v15
    v_bfe_u32 v13, v1, 2, 2
    v_and_b32 v14, 3, v1
    v_lshrrev_b32 v15, 4, v1
    v_mul_u32_u24 v58, 128, v13
    v_mul_u32_u24 v14, 8, v14
    v_mul_u32_u24 v15, 512, v15
    v_add3_u32 v58, v58, v14, v15
    v_add_u32 v52, 140288, v52
    s_lshl_b32 s40, s3, 6
    s_add_u32 s40, s40, 140288
    v_add_u32 v60, s40, v60
    s_lshl_b32 s40, s3, 1
    v_lshrrev_b32 v8, 5, v1
    v_add_u32 v10, s40, v8
    v_mul_u32_u24 v48, 528, v10
    v_and_b32 v9, 31, v1
    v_lshl_add_u32 v48, v9, 4, v48
    v_add_u32 v48, 24576, v48
    v_add_u32 v59, 0x10000, v48
    v_lshlrev_b32 v49, 3, v1
    s_lshl_b32 s52, s37, 4
    s_add_u32 s52, s52, s38
    s_mul_i32 s52, s52, 2176
    s_lshl_b32 s40, s3, 9
    s_add_u32 s52, s52, s40
    s_mul_i32 s53, s3, 34816
    s_and_b32 s40, s14, 7
    s_lshl_b32 s40, s40, 8
    s_add_u32 s53, s53, s40
    s_bfe_u32 s40, s14, 0x20003
    s_lshl_b32 s40, s40, 6
    s_add_u32 s53, s53, s40
    s_add_u32 s54, s53, 8704
    s_add_u32 s55, s53, 17408
    s_add_u32 s56, s53, 26112
    s_lshr_b32 s42, s3, 1
    s_and_b32 s43, s3, 1
    s_lshl_b32 s43, s43, 7
    s_lshr_b32 s40, s14, 5
    s_lshl_b32 s40, s40, 1
    s_add_u32 s40, s40, s42
    s_mul_i32 s57, s40, 8320
    s_and_b32 s40, s14, 31
    s_lshl_b32 s40, s40, 8
    s_add_u32 s57, s57, s40
    s_add_u32 s57, s57, s43
    s_add_u32 s57, s57, 557056
    s_and_b32 s40, s1, 7
    s_lshl_b32 s40, s40, 1
    s_add_u32 s40, s40, s42
    s_mul_i32 s59, s40, 7296
    s_add_u32 s59, s59, s43
    s_lshr_b32 s43, s1, 3
    s_lshl_b32 s42, s43, 8
    s_add_u32 s59, s59, s42
    s_add_u32 s59, s59, 1552384
    s_and_b32 s40, s63, 7
    s_lshl_b32 s58, s40, 8
    s_lshl_b32 s42, s3, 6
    s_add_u32 s58, s58, s42
    s_add_u32 s58, s58, 2369536
    s_mov_b32 s49, 2377728
    s_mul_i32 s60, s40, 57856
    s_lshr_b32 s41, s63, 3
    s_lshl_b32 s41, s41, 9
    s_add_u32 s60, s60, s41
    s_lshl_b32 s40, s3, 7
    s_add_u32 s60, s60, s40
    s_add_u32 s60, s60, 1089536
    s_lshl_b32 s43, s43, 9
    s_add_u32 s48, s43, s40
    s_add_u32 s48, s48, 1089536
    s_mov_b32 s61, 0x3f80
    s_mov_b32 s62, 0x3f800000
    s_mov_b32 s96, 0x000f000f
    s_mov_b32 s97, 0x000f000f
    s_mov_b32 s41, 0
Lsp_229:
    ds_read_b32 v4, v2 offset:80
    s_add_u32 s41, s41, 1
    s_waitcnt lgkmcnt(0)
    v_readfirstlane_b32 s40, v4
    s_nop 0
    s_cmp_ge_u32 s40, 1
    s_nop 1
    s_cbranch_scc1 Lspd_230
    s_cmp_lt_u32 s41, 131072
    s_cbranch_scc1 Lsp_229
Lspd_230:
    s_cmp_lg_u32 s3, 0
    s_cbranch_scc1 Lnof_228
    s_lshl_b32 s40, s37, 10
    s_add_u32 s40, s40, 2353152
    buffer_load_dwordx4 v[16:19], v5, s[44:47], s40 offen sc1
    s_waitcnt vmcnt(0)
    v_max3_u32 v20, v16, v17, v18
    v_max_u32 v20, v20, v19
    v_cmp_eq_u32 vcc, -1, v20
    s_nop 0
    s_cbranch_vccnz Lnof_228_y
    v_mov_b32 v20, v16
    v_mov_b32 v22, v18
    s_nop 0
    v_max_f32_dpp v20, v20, v20 row_ror:4 row_mask:0xf bank_mask:0xf
    v_max_f32_dpp v22, v22, v22 row_ror:4 row_mask:0xf bank_mask:0xf
    s_nop 0
    v_max_f32_dpp v20, v20, v20 row_ror:8 row_mask:0xf bank_mask:0xf
    v_max_f32_dpp v22, v22, v22 row_ror:8 row_mask:0xf bank_mask:0xf
    v_mov_b32 v24, v20
    v_mov_b32 v25, v22
    s_nop 0
    v_permlane16_swap_b32 v24, v20
    v_permlane16_swap_b32 v25, v22
    v_max_f32 v20, v20, v24
    v_max_f32 v22, v22, v25
    v_mov_b32 v24, v20
    v_mov_b32 v25, v22
    s_nop 0
    v_permlane32_swap_b32 v24, v20
    v_permlane32_swap_b32 v25, v22
    v_max_f32 v20, v20, v24
    v_max_f32 v22, v22, v25
    v_sub_f32 v16, v16, v20
    v_sub_f32 v18, v18, v22
    v_exp_f32 v16, v16
    v_exp_f32 v18, v18
    v_mul_f32 v21, v16, v17
    v_mul_f32 v23, v18, v19
    s_nop 0
    v_add_f32_dpp v21, v21, v21 row_ror:4 row_mask:0xf bank_mask:0xf
    v_add_f32_dpp v23, v23, v23 row_ror:4 row_mask:0xf bank_mask:0xf
    s_nop 0
    v_add_f32_dpp v21, v21, v21 row_ror:8 row_mask:0xf bank_mask:0xf
    v_add_f32_dpp v23, v23, v23 row_ror:8 row_mask:0xf bank_mask:0xf
    v_mov_b32 v24, v21
    v_mov_b32 v25, v23
    s_nop 0
    v_permlane16_swap_b32 v24, v21
    v_permlane16_swap_b32 v25, v23
    v_add_f32 v21, v21, v24
    v_add_f32 v23, v23, v25
    v_mov_b32 v24, v21
    v_mov_b32 v25, v23
    s_nop 0
    v_permlane32_swap_b32 v24, v21
    v_permlane32_swap_b32 v25, v23
    v_add_f32 v21, v21, v24
    v_add_f32 v23, v23, v25
    v_rcp_f32 v21, v21
    v_rcp_f32 v23, v23
    v_add_u32 v24, 150016, v5
    s_mov_b64 exec, 15
    ds_write_b128 v24, v[20:23]
    s_waitcnt lgkmcnt(0)
    s_mov_b64 exec, -1
    s_mov_b64 exec, 1
    ds_add_u32 v2, v3 offset:84
    s_mov_b64 exec, -1
    s_branch Lnof_228_x
Lnof_228_y:
    s_mov_b32 s41, 0
Lsp_231:
    ds_read_b32 v4, v2 offset:116
    s_add_u32 s41, s41, 1
    s_waitcnt lgkmcnt(0)
    v_readfirstlane_b32 s40, v4
    s_nop 0
    s_cmp_ge_u32 s40, 1
    s_nop 1
    s_cbranch_scc1 Lspd_232
    s_cmp_lt_u32 s41, 131072
    s_cbranch_scc1 Lsp_231
Lspd_232:
    s_lshl_b32 s40, s37, 10
    s_add_u32 s40, s40, 2353152
    buffer_load_dwordx4 v[16:19], v5, s[44:47], s40 offen sc1
    s_waitcnt vmcnt(0)
    v_max3_u32 v20, v16, v17, v18
    v_max_u32 v20, v20, v19
    v_cmp_eq_u32 vcc, -1, v20
    s_nop 0
    s_cbranch_vccnz Lnof_228_x
    v_mov_b32 v20, v16
    v_mov_b32 v22, v18
    s_nop 0
    v_max_f32_dpp v20, v20, v20 row_ror:4 row_mask:0xf bank_mask:0xf
    v_max_f32_dpp v22, v22, v22 row_ror:4 row_mask:0xf bank_mask:0xf
    s_nop 0
    v_max_f32_dpp v20, v20, v20 row_ror:8 row_mask:0xf bank_mask:0xf
    v_max_f32_dpp v22, v22, v22 row_ror:8 row_mask:0xf bank_mask:0xf
    v_mov_b32 v24, v20
    v_mov_b32 v25, v22
    s_nop 0
    v_permlane16_swap_b32 v24, v20
    v_permlane16_swap_b32 v25, v22
    v_max_f32 v20, v20, v24
    v_max_f32 v22, v22, v25
    v_mov_b32 v24, v20
    v_mov_b32 v25, v22
    s_nop 0
    v_permlane32_swap_b32 v24, v20
    v_permlane32_swap_b32 v25, v22
    v_max_f32 v20, v20, v24
    v_max_f32 v22, v22, v25
    v_sub_f32 v16, v16, v20
    v_sub_f32 v18, v18, v22
    v_exp_f32 v16, v16
    v_exp_f32 v18, v18
    v_mul_f32 v21, v16, v17
    v_mul_f32 v23, v18, v19
    s_nop 0
    v_add_f32_dpp v21, v21, v21 row_ror:4 row_mask:0xf bank_mask:0xf
    v_add_f32_dpp v23, v23, v23 row_ror:4 row_mask:0xf bank_mask:0xf
    s_nop 0
    v_add_f32_dpp v21, v21, v21 row_ror:8 row_mask:0xf bank_mask:0xf
    v_add_f32_dpp v23, v23, v23 row_ror:8 row_mask:0xf bank_mask:0xf
    v_mov_b32 v24, v21
    v_mov_b32 v25, v23
    s_nop 0
    v_permlane16_swap_b32 v24, v21
    v_permlane16_swap_b32 v25, v23
    v_add_f32 v21, v21, v24
    v_add_f32 v23, v23, v25
    v_mov_b32 v24, v21
    v_mov_b32 v25, v23
    s_nop 0
    v_permlane32_swap_b32 v24, v21
    v_permlane32_swap_b32 v25, v23
    v_add_f32 v21, v21, v24
    v_add_f32 v23, v23, v25
    v_rcp_f32 v21, v21
    v_rcp_f32 v23, v23
    v_add_u32 v24, 150016, v5
    s_mov_b64 exec, 15
    ds_write_b128 v24, v[20:23]
    s_waitcnt lgkmcnt(0)
    s_mov_b64 exec, -1
    s_mov_b64 exec, 1
    ds_add_u32 v2, v3 offset:84
    s_mov_b64 exec, -1
Lnof_228_x:
    s_mov_b64 exec, 1
    ds_add_u32 v2, v3 offset:112
    s_mov_b64 exec, -1
Lnof_228:
    v_bfe_u32 v13, v1, 2, 2
    v_and_b32 v14, 3, v1
    v_lshrrev_b32 v15, 4, v1
    v_mul_u32_u24 v212, 8, v13
    v_mul_u32_u24 v14, 32, v14
    v_mul_u32_u24 v15, 4096, v15
    v_add3_u32 v212, v212, v14, v15
    s_and_b32 s51, s63, 7
    s_lshl_b32 s51, s51, 9
    s_lshl_b32 s42, s3, 7
    s_add_u32 s51, s51, s42
    s_add_u32 s51, s51, 2381824
    s_lshl_b32 s40, s3, 4
    v_lshrrev_b32 v9, 5, v1
    v_lshl_add_u32 v8, v9, 3, s40
    v_add_u32 v9, 150016, v8
    v_add_u32 v8, 149760, v8
    ds_read_b32 v192, v8
    ds_read_b32 v193, v8 offset:64
    ds_read_b32 v194, v8 offset:128
    ds_read_b32 v195, v8 offset:192
    s_mov_b32 s41, 0
Lsp_233:
    ds_read_b32 v4, v2 offset:112
    s_add_u32 s41, s41, 1
    s_waitcnt lgkmcnt(0)
    v_readfirstlane_b32 s40, v4
    s_nop 0
    s_cmp_ge_u32 s40, 1
    s_nop 1
    s_cbranch_scc1 Lspd_234
    s_cmp_lt_u32 s41, 131072
    s_cbranch_scc1 Lsp_233
Lspd_234:
    ds_read_b32 v4, v2 offset:84
    s_waitcnt lgkmcnt(0)
    v_readfirstlane_b32 s33, v4
    s_nop 0
    s_cmp_eq_u32 s33, 0
    s_nop 1
    s_cbranch_scc1 Lnf_235
    s_mov_b32 s41, 0
Lsp_236:
    ds_read_b32 v4, v2 offset:84
    s_add_u32 s41, s41, 1
    s_waitcnt lgkmcnt(0)
    v_readfirstlane_b32 s40, v4
    s_nop 0
    s_cmp_ge_u32 s40, 1
    s_nop 1
    s_cbranch_scc1 Lspd_237
    s_cmp_lt_u32 s41, 131072
    s_cbranch_scc1 Lsp_236
Lspd_237:
    ds_read_b64 v[20:21], v9
    s_waitcnt lgkmcnt(0)
    v_sub_f32 v192, v192, v20
    v_sub_f32 v193, v193, v20
    v_sub_f32 v194, v194, v20
    v_sub_f32 v195, v195, v20
    v_exp_f32 v192, v192
    v_exp_f32 v193, v193
    v_exp_f32 v194, v194
    v_exp_f32 v195, v195
    v_mul_f32 v192, v192, v21
    v_mul_f32 v193, v193, v21
    v_mul_f32 v194, v194, v21
    v_mul_f32 v195, v195, v21
    s_nop 1
Lnf_235:
    s_setprio 2
    s_barrier
    s_cmp_eq_u32 s33, 0
    s_cbranch_scc1 Lml_238_s
Lml_238:
    ds_read_b128 v[16:19], v48
    ds_read_b128 v[20:23], v48 offset:32768
    ds_read_b128 v[24:27], v59
    ds_read_b128 v[28:31], v59 offset:32768
    s_waitcnt lgkmcnt(3)
    v_mul_f32 v16, v16, v192
    v_mul_f32 v17, v17, v192
    v_mul_f32 v18, v18, v192
    v_mul_f32 v19, v19, v192
    s_waitcnt lgkmcnt(2)
    v_fmac_f32 v16, v20, v193
    v_fmac_f32 v17, v21, v193
    v_fmac_f32 v18, v22, v193
    v_fmac_f32 v19, v23, v193
    s_waitcnt lgkmcnt(1)
    v_fmac_f32 v16, v24, v194
    v_fmac_f32 v17, v25, v194
    v_fmac_f32 v18, v26, v194
    v_fmac_f32 v19, v27, v194
    s_waitcnt lgkmcnt(0)
    v_fmac_f32 v16, v28, v195
    v_fmac_f32 v17, v29, v195
    v_fmac_f32 v18, v30, v195
    v_fmac_f32 v19, v31, v195
    v_cvt_pk_bf16_f32 v16, v16, v17
    v_cvt_pk_bf16_f32 v17, v18, v19
    v_min_u32 v16, -2, v16
    v_min_u32 v17, -2, v17
    buffer_store_dwordx2 v[16:17], v49, s[44:47], s52 offen sc1
    s_cmp_lt_u32 s99, 192
    s_cbranch_scc1 Lnonp_239
    s_cmp_ge_u32 s3, 2
    s_cbranch_scc1 Lnopub_240
    s_lshl_b32 s40, s34, 1
    s_add_u32 s40, s40, s3
    s_mul_i32 s40, s40, 24832
    s_lshl_b32 s41, s39, 9
    s_add_u32 s40, s40, s41
    s_add_u32 s40, s40, 2011136
    v_lshrrev_b32 v8, 5, v1
    v_mul_u32_u24 v8, 12416, v8
    v_and_b32 v9, 31, v1
    v_lshl_add_u32 v8, v9, 4, v8
    buffer_store_dwordx4 v[224:227], v8, s[44:47], s40 offen sc1
    s_nop 1
Lnopub_240:
    s_cmp_lt_u32 s99, 224
    s_cbranch_scc1 Lnonp_239
    s_cmp_ge_u32 s3, 2
    s_cbranch_scc1 Lnopub_241
    s_lshl_b32 s40, s34, 1
    s_add_u32 s40, s40, s3
    s_mul_i32 s40, s40, 24832
    s_lshl_b32 s41, s101, 9
    s_add_u32 s40, s40, s41
    s_add_u32 s40, s40, 2011136
    v_lshrrev_b32 v8, 5, v1
    v_mul_u32_u24 v8, 12416, v8
    v_and_b32 v9, 31, v1
    v_lshl_add_u32 v8, v9, 4, v8
    buffer_store_dwordx4 v[228:231], v8, s[44:47], s40 offen sc1
    s_nop 1
Lnopub_241:
Lnonp_239:
    s_waitcnt vmcnt(0)
    s_cmp_ge_u32 s99, 224
    s_cselect_b32 s15, 1, 0
    s_mov_b32 s41, 0
Lh1_242:
    buffer_load_dwordx4 v[16:19], v50, s[44:47], s53 offen sc1
    buffer_load_dwordx4 v[20:23], v50, s[44:47], s54 offen sc1
    buffer_load_dwordx4 v[24:27], v50, s[44:47], s55 offen sc1
    buffer_load_dwordx4 v[28:31], v50, s[44:47], s56 offen sc1
    s_add_u32 s41, s41, 1
    s_waitcnt vmcnt(3)
    v_lshlrev_b32 v32, 16, v16
    v_and_b32 v33, 0xffff0000, v16
    v_lshlrev_b32 v34, 16, v17
    v_and_b32 v35, 0xffff0000, v17
    v_lshlrev_b32 v36, 16, v18
    v_and_b32 v37, 0xffff0000, v18
    v_lshlrev_b32 v38, 16, v19
    v_and_b32 v39, 0xffff0000, v19
    s_waitcnt vmcnt(2)
    v_dot2_f32_bf16 v32, v20, s61, v32
    v_dot2_f32_bf16 v33, v20, s62, v33
    v_dot2_f32_bf16 v34, v21, s61, v34
    v_dot2_f32_bf16 v35, v21, s62, v35
    v_dot2_f32_bf16 v36, v22, s61, v36
    v_dot2_f32_bf16 v37, v22, s62, v37
    v_dot2_f32_bf16 v38, v23, s61, v38
    v_dot2_f32_bf16 v39, v23, s62, v39
    s_waitcnt vmcnt(1)
    v_dot2_f32_bf16 v32, v24, s61, v32
    v_dot2_f32_bf16 v33, v24, s62, v33
    v_dot2_f32_bf16 v34, v25, s61, v34
    v_dot2_f32_bf16 v35, v25, s62, v35
    v_dot2_f32_bf16 v36, v26, s61, v36
    v_dot2_f32_bf16 v37, v26, s62, v37
    v_dot2_f32_bf16 v38, v27, s61, v38
    v_dot2_f32_bf16 v39, v27, s62, v39
    s_waitcnt vmcnt(0)
    v_dot2_f32_bf16 v32, v28, s61, v32
    v_dot2_f32_bf16 v33, v28, s62, v33
    v_dot2_f32_bf16 v34, v29, s61, v34
    v_dot2_f32_bf16 v35, v29, s62, v35
    v_dot2_f32_bf16 v36, v30, s61, v36
    v_dot2_f32_bf16 v37, v30, s62, v37
    v_dot2_f32_bf16 v38, v31, s61, v38
    v_dot2_f32_bf16 v39, v31, s62, v39
    v_add_f32 v40, v32, v34
    s_nop 0
    v_add_f32 v41, v36, v38
    v_cmp_u_f32 vcc, v40, v41
    s_nop 0
    s_cbranch_vccz Lh1d_243
    v_max3_u32 v4, v16, v17, v18
    v_max3_u32 v4, v4, v19, v20
    v_max3_u32 v4, v4, v21, v22
    v_max3_u32 v4, v4, v23, v24
    v_max3_u32 v4, v4, v25, v26
    v_max3_u32 v4, v4, v27, v28
    v_max3_u32 v4, v4, v29, v30
    v_max_u32 v4, v4, v31
    v_cmp_eq_u32 vcc, -1, v4
    s_nop 0
    s_cbranch_vccz Lh1d_243
    s_mov_b64 exec, vcc
    s_sleep 1
    s_cmp_lt_u32 s41, 8192
    s_cbranch_scc1 Lh1_242
Lh1d_243:
    s_mov_b64 exec, -1
    v_add_f32_dpp v32, v32, v32 row_ror:4 row_mask:0xf bank_mask:0xf
    v_add_f32_dpp v33, v33, v33 row_ror:4 row_mask:0xf bank_mask:0xf
    v_add_f32_dpp v34, v34, v34 row_ror:4 row_mask:0xf bank_mask:0xf
    v_add_f32_dpp v35, v35, v35 row_ror:4 row_mask:0xf bank_mask:0xf
    v_add_f32_dpp v36, v36, v36 row_ror:4 row_mask:0xf bank_mask:0xf
    v_add_f32_dpp v37, v37, v37 row_ror:4 row_mask:0xf bank_mask:0xf
    v_add_f32_dpp v38, v38, v38 row_ror:4 row_mask:0xf bank_mask:0xf
    v_add_f32_dpp v39, v39, v39 row_ror:4 row_mask:0xf bank_mask:0xf
    v_add_f32_dpp v32, v32, v32 row_ror:8 row_mask:0xf bank_mask:0xf
    v_add_f32_dpp v33, v33, v33 row_ror:8 row_mask:0xf bank_mask:0xf
    v_add_f32_dpp v34, v34, v34 row_ror:8 row_mask:0xf bank_mask:0xf
    v_add_f32_dpp v35, v35, v35 row_ror:8 row_mask:0xf bank_mask:0xf
    v_add_f32_dpp v36, v36, v36 row_ror:8 row_mask:0xf bank_mask:0xf
    v_add_f32_dpp v37, v37, v37 row_ror:8 row_mask:0xf bank_mask:0xf
    v_add_f32_dpp v38, v38, v38 row_ror:8 row_mask:0xf bank_mask:0xf
    v_add_f32_dpp v39, v39, v39 row_ror:8 row_mask:0xf bank_mask:0xf
    v_cvt_pk_bf16_f32 v40, v32, v33
    v_cvt_pk_bf16_f32 v41, v34, v35
    v_cvt_pk_bf16_f32 v42, v36, v37
    v_cvt_pk_bf16_f32 v43, v38, v39
    s_mov_b64 exec, s[96:97]
    ds_write_b128 v60, v[40:43]
    s_mov_b64 exec, -1
    s_waitcnt lgkmcnt(0)
    s_barrier
    ds_read_b128 v[16:19], v52 offset:0
    ds_read_b128 v[20:23], v52 offset:64
    ds_read_b128 v[24:27], v52 offset:128
    ds_read_b128 v[28:31], v52 offset:192
    s_waitcnt lgkmcnt(3)
    v_mfma_f32_16x16x32_bf16 v[32:35], v[16:19], v[160:163], 0
    v_mfma_f32_16x16x32_bf16 v[36:39], v[16:19], v[164:167], 0
    s_waitcnt lgkmcnt(2)
    v_mfma_f32_16x16x32_bf16 v[32:35], v[20:23], v[168:171], v[32:35]
    v_mfma_f32_16x16x32_bf16 v[36:39], v[20:23], v[172:175], v[36:39]
    s_waitcnt lgkmcnt(1)
    v_mfma_f32_16x16x32_bf16 v[32:35], v[24:27], v[176:179], v[32:35]
    v_mfma_f32_16x16x32_bf16 v[36:39], v[24:27], v[180:183], v[36:39]
    s_waitcnt lgkmcnt(0)
    v_mfma_f32_16x16x32_bf16 v[32:35], v[28:31], v[184:187], v[32:35]
    v_mfma_f32_16x16x32_bf16 v[36:39], v[28:31], v[188:191], v[36:39]
    s_nop 6
    v_min_u32 v32, -2, v32
    buffer_store_dword v32, v53, s[44:47], s57 offen offset:0 sc1
    v_min_u32 v36, -2, v36
    buffer_store_dword v36, v53, s[44:47], s57 offen offset:64 sc1
    s_cmp_ge_u32 s99, 224
    s_cbranch_scc1 L_red
    s_cmp_eq_u32 s0, 0
    s_cbranch_scc1 Lnogp_244
    s_cmp_ge_u32 s3, 2
    s_cbranch_scc1 Lnogp_244
    s_and_b32 s42, s101, 7
    s_lshr_b32 s43, s101, 3
    s_cmp_ge_u32 s3, 2
    s_cbranch_scc1 Lnosum_245
    ds_read_b128 v[24:27], v7 offset:0
    ds_read_b128 v[28:31], v7 offset:2304
    ds_read_b128 v[32:35], v7 offset:4608
    ds_read_b128 v[36:39], v7 offset:6912
    s_waitcnt lgkmcnt(0)
    v_pk_add_f32 v[24:25], v[24:25], v[28:29]
    v_pk_add_f32 v[26:27], v[26:27], v[30:31]
    v_pk_add_f32 v[32:33], v[32:33], v[36:37]
    v_pk_add_f32 v[34:35], v[34:35], v[38:39]
    v_pk_add_f32 v[24:25], v[24:25], v[32:33]
    v_pk_add_f32 v[26:27], v[26:27], v[34:35]
    v_min_u32 v24, -2, v24
    v_min_u32 v25, -2, v25
    v_min_u32 v26, -2, v26
    v_min_u32 v27, -2, v27
    s_nop 1
Lnosum_245:
    s_cmp_ge_u32 s3, 2
    s_cbranch_scc1 Lnopub_246
    s_lshl_b32 s40, s42, 1
    s_add_u32 s40, s40, s3
    s_mul_i32 s40, s40, 8448
    s_lshl_b32 s41, s43, 9
    s_add_u32 s40, s40, s41
    s_add_u32 s40, s40, 2217984
    v_lshrrev_b32 v8, 5, v1
    v_mul_u32_u24 v8, 4224, v8
    v_and_b32 v9, 31, v1
    v_lshl_add_u32 v8, v9, 4, v8
    buffer_store_dwordx4 v[24:27], v8, s[44:47], s40 offen sc1
    s_nop 1
Lnopub_246:
    s_branch Lnogp_244_d
Lnogp_244:
    s_sleep 4
Lnogp_244_d:
    s_sleep 49
    buffer_load_dword v16, v57, s[44:47], s58 offen offset:0 sc1
    buffer_load_dwordx2 v[20:21], v58, s[44:47], s49 offen offset:0 sc1
    buffer_load_dwordx2 v[214:215], v212, s[44:47], s51 offen offset:0 sc1
    s_waitcnt vmcnt(0)
    v_lshlrev_b32 v204, 16, v214
    v_lshlrev_b32 v205, 16, v215
    v_and_b32 v206, 0xffff0000, v214
    v_and_b32 v207, 0xffff0000, v215
    v_lshlrev_b32 v32, 16, v16
    v_and_b32 v33, 0xffff0000, v16
    v_add_f32_dpp v20, v20, v20 row_ror:1 row_mask:0xf bank_mask:0xf
    v_add_f32_dpp v21, v21, v21 row_ror:1 row_mask:0xf bank_mask:0xf
    s_nop 0
    v_add_f32_dpp v20, v20, v20 row_ror:2 row_mask:0xf bank_mask:0xf
    v_add_f32_dpp v21, v21, v21 row_ror:2 row_mask:0xf bank_mask:0xf
    s_nop 0
    v_add_f32_dpp v20, v20, v20 row_ror:4 row_mask:0xf bank_mask:0xf
    v_add_f32_dpp v21, v21, v21 row_ror:4 row_mask:0xf bank_mask:0xf
    s_nop 0
    v_add_f32_dpp v20, v20, v20 row_ror:8 row_mask:0xf bank_mask:0xf
    v_add_f32_dpp v21, v21, v21 row_ror:8 row_mask:0xf bank_mask:0xf
    v_mul_f32 v20, 0x3a800000, v20
    v_mul_f32 v21, 0x3a800000, v21
    v_fma_f32 v21, -v20, v20, v21
    v_cmp_u_f32 s[42:43], v21, v21
    v_max_f32 v21, 0, v21
    v_add_f32 v21, 0x3727c5ac, v21
    v_rsq_f32 v21, v21
    v_sub_f32 v32, v32, v20
    v_sub_f32 v33, v33, v20
    v_mul_f32 v32, v32, v21
    v_mul_f32 v33, v33, v21
    v_fma_f32 v32, v32, v204, v206
    v_fma_f32 v33, v33, v205, v207
    v_cvt_pk_bf16_f32 v16, v32, v33
    ds_write_b32 v60, v16 offset:1280
    v_cmp_u_f32 vcc, v32, v33
    s_nop 0
    s_or_b64 vcc, vcc, s[42:43]
    s_cbranch_vccnz Lfd_247_s
Lfd_247:
    s_waitcnt lgkmcnt(0)
    s_barrier
    ds_read_b128 v[16:19], v52 offset:1280
    ds_read_b128 v[20:23], v52 offset:1344
    ds_read_b128 v[24:27], v52 offset:1408
    ds_read_b128 v[28:31], v52 offset:1472
    s_waitcnt lgkmcnt(3)
    v_mfma_f32_16x16x32_bf16 v[32:35], v[16:19], v[96:99], 0
    v_mfma_f32_16x16x32_bf16 v[36:39], v[16:19], v[100:103], 0
    v_mfma_f32_16x16x32_bf16 v[40:43], v[16:19], v[128:131], 0
    v_mfma_f32_16x16x32_bf16 v[44:47], v[16:19], v[132:135], 0
    s_waitcnt lgkmcnt(2)
    v_mfma_f32_16x16x32_bf16 v[32:35], v[20:23], v[104:107], v[32:35]
    v_mfma_f32_16x16x32_bf16 v[36:39], v[20:23], v[108:111], v[36:39]
    v_mfma_f32_16x16x32_bf16 v[40:43], v[20:23], v[136:139], v[40:43]
    v_mfma_f32_16x16x32_bf16 v[44:47], v[20:23], v[140:143], v[44:47]
    s_waitcnt lgkmcnt(1)
    v_mfma_f32_16x16x32_bf16 v[32:35], v[24:27], v[112:115], v[32:35]
    v_mfma_f32_16x16x32_bf16 v[36:39], v[24:27], v[116:119], v[36:39]
    v_mfma_f32_16x16x32_bf16 v[40:43], v[24:27], v[144:147], v[40:43]
    v_mfma_f32_16x16x32_bf16 v[44:47], v[24:27], v[148:151], v[44:47]
    s_waitcnt lgkmcnt(0)
    v_mfma_f32_16x16x32_bf16 v[32:35], v[28:31], v[120:123], v[32:35]
    v_mfma_f32_16x16x32_bf16 v[36:39], v[28:31], v[124:127], v[36:39]
    v_mfma_f32_16x16x32_bf16 v[40:43], v[28:31], v[152:155], v[40:43]
    v_mfma_f32_16x16x32_bf16 v[44:47], v[28:31], v[156:159], v[44:47]
    s_add_u32 s52, s48, 57856
    s_add_u32 s53, s48, 115712
    s_add_u32 s54, s48, 173568
    s_add_u32 s55, s48, 231424
    s_add_u32 s56, s48, 289280
    s_add_u32 s57, s48, 347136
    s_add_u32 s58, s48, 404992
    v_cvt_pk_bf16_f32 v32, v32, v40
    v_cvt_pk_bf16_f32 v36, v36, v44
    v_min_u32 v32, -2, v32
    v_min_u32 v36, -2, v36
    s_cmp_lg_u32 s36, 0
    s_cbranch_scc1 Lgl_248
    buffer_store_dword v32, v51, s[44:47], s60 offen sc1
    buffer_store_dword v36, v51, s[44:47], s60 offen offset:64 sc1
    s_branch Lgld_249
Lgl_248:
    buffer_store_dword v32, v51, s[44:47], s60 offen
    buffer_store_dword v36, v51, s[44:47], s60 offen offset:64
Lgld_249:
    s_waitcnt vmcnt(0)
    s_sleep 2
    buffer_load_dwordx2 v[16:17], v55, s[44:47], s48 offen offset:0 sc1
    buffer_load_dwordx2 v[18:19], v55, s[44:47], s52 offen offset:0 sc1
    buffer_load_dwordx2 v[20:21], v55, s[44:47], s53 offen offset:0 sc1
    buffer_load_dwordx2 v[22:23], v55, s[44:47], s54 offen offset:0 sc1
    buffer_load_dwordx2 v[24:25], v55, s[44:47], s55 offen offset:0 sc1
    buffer_load_dwordx2 v[26:27], v55, s[44:47], s56 offen offset:0 sc1
    buffer_load_dwordx2 v[28:29], v55, s[44:47], s57 offen offset:0 sc1
    buffer_load_dwordx2 v[30:31], v55, s[44:47], s58 offen offset:0 sc1
    s_waitcnt vmcnt(7)
    v_lshlrev_b32 v32, 16, v16
    v_and_b32 v33, 0xffff0000, v16
    v_lshlrev_b32 v34, 16, v17
    v_and_b32 v35, 0xffff0000, v17
    s_waitcnt vmcnt(6)
    v_dot2_f32_bf16 v32, v18, s61, v32
    v_dot2_f32_bf16 v33, v18, s62, v33
    v_dot2_f32_bf16 v34, v19, s61, v34
    v_dot2_f32_bf16 v35, v19, s62, v35
    s_waitcnt vmcnt(5)
    v_dot2_f32_bf16 v32, v20, s61, v32
    v_dot2_f32_bf16 v33, v20, s62, v33
    v_dot2_f32_bf16 v34, v21, s61, v34
    v_dot2_f32_bf16 v35, v21, s62, v35
    s_waitcnt vmcnt(4)
    v_dot2_f32_bf16 v32, v22, s61, v32
    v_dot2_f32_bf16 v33, v22, s62, v33
    v_dot2_f32_bf16 v34, v23, s61, v34
    v_dot2_f32_bf16 v35, v23, s62, v35
    s_waitcnt vmcnt(3)
    v_dot2_f32_bf16 v32, v24, s61, v32
    v_dot2_f32_bf16 v33, v24, s62, v33
    v_dot2_f32_bf16 v34, v25, s61, v34
    v_dot2_f32_bf16 v35, v25, s62, v35
    s_waitcnt vmcnt(2)
    v_dot2_f32_bf16 v32, v26, s61, v32
    v_dot2_f32_bf16 v33, v26, s62, v33
    v_dot2_f32_bf16 v34, v27, s61, v34
    v_dot2_f32_bf16 v35, v27, s62, v35
    s_waitcnt vmcnt(1)
    v_dot2_f32_bf16 v32, v28, s61, v32
    v_dot2_f32_bf16 v33, v28, s62, v33
    v_dot2_f32_bf16 v34, v29, s61, v34
    v_dot2_f32_bf16 v35, v29, s62, v35
    s_waitcnt vmcnt(0)
    v_dot2_f32_bf16 v32, v30, s61, v32
    v_dot2_f32_bf16 v33, v30, s62, v33
    v_dot2_f32_bf16 v34, v31, s61, v34
    v_dot2_f32_bf16 v35, v31, s62, v35
    s_nop 1
    v_cmp_u_f32 vcc, v32, v34
    s_nop 0
    s_cbranch_vccnz Lfd_250_s
Lfd_250:
    v_cvt_pk_bf16_f32 v20, v32, v33
    v_lshlrev_b32 v32, 16, v20
    v_and_b32 v33, 0xffff0000, v20
    v_cvt_pk_bf16_f32 v21, v34, v35
    v_lshlrev_b32 v34, 16, v21
    v_and_b32 v35, 0xffff0000, v21
    v_mul_f32 v20, 0xbfb8aa3b, v32
    v_mul_f32 v21, 0xbfb8aa3b, v34
    v_exp_f32 v20, v20
    v_exp_f32 v21, v21
    v_add_f32 v20, 1.0, v20
    v_add_f32 v21, 1.0, v21
    v_rcp_f32 v20, v20
    v_rcp_f32 v21, v21
    v_mul_f32 v32, v32, v20
    v_mul_f32 v34, v34, v21
    v_cvt_pk_bf16_f32 v20, v32, v34
    v_lshlrev_b32 v32, 16, v20
    v_and_b32 v34, 0xffff0000, v20
    v_mul_f32 v32, v32, v33
    v_mul_f32 v34, v34, v35
    v_cvt_pk_bf16_f32 v16, v32, v34
    ds_write_b32 v60, v16
    s_waitcnt lgkmcnt(0)
    s_barrier
    ds_read_b128 v[16:19], v52 offset:0
    ds_read_b128 v[20:23], v52 offset:64
    ds_read_b128 v[24:27], v52 offset:128
    ds_read_b128 v[28:31], v52 offset:192
    s_waitcnt lgkmcnt(3)
    v_mfma_f32_16x16x32_bf16 v[32:35], v[16:19], v[64:67], 0
    v_mfma_f32_16x16x32_bf16 v[36:39], v[16:19], v[68:71], 0
    s_waitcnt lgkmcnt(2)
    v_mfma_f32_16x16x32_bf16 v[32:35], v[20:23], v[72:75], v[32:35]
    v_mfma_f32_16x16x32_bf16 v[36:39], v[20:23], v[76:79], v[36:39]
    s_waitcnt lgkmcnt(1)
    v_mfma_f32_16x16x32_bf16 v[32:35], v[24:27], v[80:83], v[32:35]
    v_mfma_f32_16x16x32_bf16 v[36:39], v[24:27], v[84:87], v[36:39]
    s_waitcnt lgkmcnt(0)
    v_mfma_f32_16x16x32_bf16 v[32:35], v[28:31], v[88:91], v[32:35]
    v_mfma_f32_16x16x32_bf16 v[36:39], v[28:31], v[92:95], v[36:39]
    s_nop 6
    v_min_u32 v32, -2, v32
    buffer_store_dword v32, v56, s[44:47], s59 offen offset:0 sc1
    v_min_u32 v36, -2, v36
    buffer_store_dword v36, v56, s[44:47], s59 offen offset:64 sc1
    s_branch L_fin
L_red:
    s_cmp_ge_u32 s3, 2
    s_cbranch_scc1 L_ts
    s_mul_i32 s40, s98, 8320
    s_add_u32 s40, s40, 557056
    s_add_u32 s51, s40, 4096
    s_lshl_b32 s52, s98, 7
    s_add_u32 s52, s52, 2369536
    s_lshr_b32 s53, s98, 2
    s_lshl_b32 s53, s53, 7
    s_and_b32 s54, s98, 3
    s_lshl_b32 s54, s54, 3
    s_add_u32 s53, s53, s54
    s_add_u32 s53, s53, 2377728
    s_mov_b32 s54, 0xffff
    s_mov_b32 s55, 0xffff
    v_mov_b32 v61, 0
    v_bfe_u32 v13, v1, 2, 2
    v_and_b32 v14, 3, v1
    v_lshrrev_b32 v15, 4, v1
    v_mul_u32_u24 v8, 64, v13
    v_mul_u32_u24 v14, 16, v14
    v_mul_u32_u24 v15, 49664, v15
    v_add3_u32 v8, v8, v14, v15
    s_lshr_b32 s42, s98, 4
    s_mul_i32 s42, s42, 12416
    s_and_b32 s43, s98, 15
    s_lshl_b32 s43, s43, 8
    s_add_u32 s42, s42, s43
    s_add_u32 s12, s42, 2019328
    s_mov_b32 s41, 0
Lg_252:
    buffer_load_dwordx4 v[32:35], v8, s[44:47], s12 offen offset:0 sc1
    s_waitcnt vmcnt(0)
    v_max3_u32 v4, v32, v33, v34
    v_max_u32 v4, v4, v35
    v_cmp_eq_u32 vcc, -1, v4
    s_add_u32 s41, s41, 1
    s_cbranch_vccz Lgd_253
    s_mov_b64 exec, vcc
    s_sleep 1
    s_cmp_lt_u32 s41, 8192
    s_cbranch_scc1 Lg_252
Lgd_253:
    s_mov_b64 exec, -1
    v_permlane32_swap_b32 v32, v34
    v_permlane32_swap_b32 v33, v35
    v_pk_add_f32 v[32:33], v[32:33], v[34:35]
    v_mov_b32 v34, v32
    v_mov_b32 v35, v33
    s_nop 0
    v_permlane16_swap_b32 v34, v32
    v_permlane16_swap_b32 v35, v33
    v_pk_add_f32 v[32:33], v[32:33], v[34:35]
    v_mov_b32 v68, v32
    v_mov_b32 v69, v33
    v_cvt_pk_bf16_f32 v26, v68, v69
    v_lshlrev_b32 v68, 16, v26
    v_and_b32 v69, 0xffff0000, v26
    s_sleep 1
    buffer_load_dwordx4 v[16:19], v5, s[44:47], s40 offen offset:0 sc1
    buffer_load_dwordx4 v[20:23], v5, s[44:47], s40 offen offset:1024 sc1
    buffer_load_dwordx4 v[24:27], v5, s[44:47], s40 offen offset:2048 sc1
    buffer_load_dwordx4 v[28:31], v5, s[44:47], s40 offen offset:3072 sc1
    buffer_load_dwordx4 v[32:35], v5, s[44:47], s51 offen offset:0 sc1
    buffer_load_dwordx4 v[36:39], v5, s[44:47], s51 offen offset:1024 sc1
    buffer_load_dwordx4 v[40:43], v5, s[44:47], s51 offen offset:2048 sc1
    buffer_load_dwordx4 v[44:47], v5, s[44:47], s51 offen offset:3072 sc1
    s_waitcnt vmcnt(6)
    v_pk_add_f32 v[16:17], v[16:17], v[20:21]
    v_pk_add_f32 v[18:19], v[18:19], v[22:23]
    s_waitcnt vmcnt(5)
    v_pk_add_f32 v[16:17], v[16:17], v[24:25]
    v_pk_add_f32 v[18:19], v[18:19], v[26:27]
    s_waitcnt vmcnt(4)
    v_pk_add_f32 v[16:17], v[16:17], v[28:29]
    v_pk_add_f32 v[18:19], v[18:19], v[30:31]
    s_waitcnt vmcnt(3)
    v_pk_add_f32 v[16:17], v[16:17], v[32:33]
    v_pk_add_f32 v[18:19], v[18:19], v[34:35]
    s_waitcnt vmcnt(2)
    v_pk_add_f32 v[16:17], v[16:17], v[36:37]
    v_pk_add_f32 v[18:19], v[18:19], v[38:39]
    s_waitcnt vmcnt(1)
    v_pk_add_f32 v[16:17], v[16:17], v[40:41]
    v_pk_add_f32 v[18:19], v[18:19], v[42:43]
    s_waitcnt vmcnt(0)
    v_pk_add_f32 v[16:17], v[16:17], v[44:45]
    v_pk_add_f32 v[18:19], v[18:19], v[46:47]
    s_nop 1
    v_permlane32_swap_b32 v16, v18
    v_permlane32_swap_b32 v17, v19
    v_pk_add_f32 v[16:17], v[16:17], v[18:19]
    v_mov_b32 v18, v16
    v_mov_b32 v19, v17
    s_nop 0
    v_permlane16_swap_b32 v18, v16
    v_permlane16_swap_b32 v19, v17
    v_pk_add_f32 v[16:17], v[16:17], v[18:19]
    v_cmp_u_f32 vcc, v16, v17
    s_nop 0
    s_cbranch_vccnz Lfd_254_s
Lfd_254:
    v_cvt_pk_bf16_f32 v18, v16, v17
    v_lshlrev_b32 v16, 16, v18
    v_and_b32 v17, 0xffff0000, v18
    v_pk_mul_f32 v[16:17], v[16:17], v[68:69]
    v_cvt_pk_bf16_f32 v18, v16, v17
    v_lshlrev_b32 v16, 16, v18
    v_and_b32 v17, 0xffff0000, v18
    v_pk_add_f32 v[16:17], v[16:17], v[66:67]
    v_cvt_pk_bf16_f32 v16, v16, v17
    v_min_u32 v16, -2, v16
    v_lshlrev_b32 v66, 16, v16
    v_and_b32 v67, 0xffff0000, v16
    s_mov_b64 exec, s[54:55]
    buffer_store_dword v16, v63, s[44:47], s52 offen sc1
    s_mov_b64 exec, -1
    v_add_f32 v18, v66, v67
    v_mul_f32 v19, v66, v66
    v_fmac_f32 v19, v67, v67
    v_add_f32_dpp v18, v18, v18 row_ror:8 row_mask:0xf bank_mask:0xf
    s_nop 0
    v_add_f32_dpp v19, v19, v19 row_ror:8 row_mask:0xf bank_mask:0xf
    v_add_f32_dpp v18, v18, v18 row_ror:4 row_mask:0xf bank_mask:0xf
    s_nop 0
    v_add_f32_dpp v19, v19, v19 row_ror:4 row_mask:0xf bank_mask:0xf
    v_add_f32_dpp v18, v18, v18 row_ror:2 row_mask:0xf bank_mask:0xf
    s_nop 0
    v_add_f32_dpp v19, v19, v19 row_ror:2 row_mask:0xf bank_mask:0xf
    v_add_f32_dpp v18, v18, v18 row_ror:1 row_mask:0xf bank_mask:0xf
    s_nop 0
    v_add_f32_dpp v19, v19, v19 row_ror:1 row_mask:0xf bank_mask:0xf
    v_mov_b32 v20, v18
    v_mov_b32 v21, v19
    s_nop 0
    v_permlane32_swap_b32 v20, v18
    v_permlane32_swap_b32 v21, v19
    v_add_f32 v18, v18, v20
    v_add_f32 v19, v19, v21
    v_min_u32 v18, -2, v18
    v_min_u32 v19, -2, v19
    s_mov_b64 exec, 1
    buffer_store_dwordx2 v[18:19], v61, s[44:47], s53 offen sc1
    s_mov_b64 exec, -1
    v_bfe_u32 v13, v1, 2, 2
    v_and_b32 v14, 3, v1
    v_lshrrev_b32 v15, 4, v1
    v_mul_u32_u24 v8, 64, v13
    v_mul_u32_u24 v14, 16, v14
    v_mul_u32_u24 v15, 16896, v15
    v_add3_u32 v8, v8, v14, v15
    s_lshr_b32 s42, s98, 4
    s_mul_i32 s42, s42, 4224
    s_and_b32 s43, s98, 15
    s_lshl_b32 s43, s43, 8
    s_add_u32 s42, s42, s43
    s_add_u32 s12, s42, 2217984
    s_add_u32 s13, s12, 67584
    s_mov_b32 s41, 0
Lg_255:
    buffer_load_dwordx4 v[28:31], v8, s[44:47], s12 offen offset:0 sc1
    buffer_load_dwordx4 v[32:35], v8, s[44:47], s13 offen offset:0 sc1
    s_waitcnt vmcnt(0)
    v_max3_u32 v4, v28, v29, v30
    v_max3_u32 v4, v4, v31, v32
    v_max3_u32 v4, v4, v33, v34
    v_max_u32 v4, v4, v35
    v_cmp_eq_u32 vcc, -1, v4
    s_add_u32 s41, s41, 1
    s_cbranch_vccz Lgd_256
    s_mov_b64 exec, vcc
    s_sleep 1
    s_cmp_lt_u32 s41, 8192
    s_cbranch_scc1 Lg_255
Lgd_256:
    s_mov_b64 exec, -1
    v_pk_add_f32 v[28:29], v[28:29], v[32:33]
    v_pk_add_f32 v[30:31], v[30:31], v[34:35]
    s_nop 1
    v_permlane32_swap_b32 v28, v30
    v_permlane32_swap_b32 v29, v31
    v_pk_add_f32 v[28:29], v[28:29], v[30:31]
    v_mov_b32 v30, v28
    v_mov_b32 v31, v29
    s_nop 0
    v_permlane16_swap_b32 v30, v28
    v_permlane16_swap_b32 v31, v29
    v_pk_add_f32 v[28:29], v[28:29], v[30:31]
    v_mov_b32 v70, v28
    v_mov_b32 v71, v29
    v_cvt_pk_bf16_f32 v26, v70, v71
    v_lshlrev_b32 v70, 16, v26
    v_and_b32 v71, 0xffff0000, v26
    s_mul_i32 s40, s98, 7296
    s_add_u32 s40, s40, 1552384
    s_add_u32 s51, s40, 4096
    s_lshl_b32 s52, s98, 7
    v_add_u32 v8, s52, v63
    s_sleep 74
    s_cmp_lg_u32 s36, 0
    s_cbranch_scc1 Lz_257
    s_sleep 8
Lz_257:
    buffer_load_dwordx4 v[16:19], v5, s[44:47], s40 offen offset:0 sc1
    buffer_load_dwordx4 v[20:23], v5, s[44:47], s40 offen offset:1024 sc1
    buffer_load_dwordx4 v[24:27], v5, s[44:47], s40 offen offset:2048 sc1
    buffer_load_dwordx4 v[28:31], v5, s[44:47], s40 offen offset:3072 sc1
    buffer_load_dwordx4 v[32:35], v5, s[44:47], s51 offen offset:0 sc1
    buffer_load_dwordx4 v[36:39], v5, s[44:47], s51 offen offset:1024 sc1
    buffer_load_dwordx4 v[40:43], v5, s[44:47], s51 offen offset:2048 sc1
    s_waitcnt vmcnt(5)
    v_pk_add_f32 v[16:17], v[16:17], v[20:21]
    v_pk_add_f32 v[18:19], v[18:19], v[22:23]
    s_waitcnt vmcnt(4)
    v_pk_add_f32 v[16:17], v[16:17], v[24:25]
    v_pk_add_f32 v[18:19], v[18:19], v[26:27]
    s_waitcnt vmcnt(3)
    v_pk_add_f32 v[16:17], v[16:17], v[28:29]
    v_pk_add_f32 v[18:19], v[18:19], v[30:31]
    s_waitcnt vmcnt(2)
    v_pk_add_f32 v[16:17], v[16:17], v[32:33]
    v_pk_add_f32 v[18:19], v[18:19], v[34:35]
    s_waitcnt vmcnt(1)
    v_pk_add_f32 v[16:17], v[16:17], v[36:37]
    v_pk_add_f32 v[18:19], v[18:19], v[38:39]
    s_waitcnt vmcnt(0)
    v_pk_add_f32 v[16:17], v[16:17], v[40:41]
    v_pk_add_f32 v[18:19], v[18:19], v[42:43]
    s_nop 1
    v_permlane32_swap_b32 v16, v18
    v_permlane32_swap_b32 v17, v19
    v_pk_add_f32 v[16:17], v[16:17], v[18:19]
    v_mov_b32 v18, v16
    v_mov_b32 v19, v17
    s_nop 0
    v_permlane16_swap_b32 v18, v16
    v_permlane16_swap_b32 v19, v17
    v_pk_add_f32 v[16:17], v[16:17], v[18:19]
    v_cmp_u_f32 vcc, v16, v17
    s_nop 0
    s_cbranch_vccnz Lfd_258_s
Lfd_258:
    v_cvt_pk_bf16_f32 v18, v16, v17
    v_lshlrev_b32 v16, 16, v18
    v_and_b32 v17, 0xffff0000, v18
    v_pk_mul_f32 v[16:17], v[16:17], v[70:71]
    v_cvt_pk_bf16_f32 v18, v16, v17
    v_lshlrev_b32 v16, 16, v18
    v_and_b32 v17, 0xffff0000, v18
    v_pk_add_f32 v[16:17], v[16:17], v[66:67]
    v_cvt_pk_bf16_f32 v16, v16, v17
    s_mov_b64 exec, s[54:55]
    global_store_dword v8, v16, s[26:27]
    s_mov_b64 exec, -1
L_fin:
    s_endpgm
Lml_238_s:
    s_cmp_lg_u32 s3, 0
    s_cbranch_scc1 Lml_238_f
    s_lshl_b32 s40, s37, 10
    s_add_u32 s40, s40, 2353152
    s_mov_b32 s41, 0
Lg_259:
    buffer_load_dwordx4 v[16:19], v5, s[44:47], s40 offen offset:0 sc1
    s_waitcnt vmcnt(0)
    v_max3_u32 v4, v16, v17, v18
    v_max_u32 v4, v4, v19
    v_cmp_eq_u32 vcc, -1, v4
    s_add_u32 s41, s41, 1
    s_cbranch_vccz Lgd_260
    s_mov_b64 exec, vcc
    s_sleep 4
    s_cmp_lt_u32 s41, 8192
    s_cbranch_scc1 Lg_259
Lgd_260:
    s_mov_b64 exec, -1
    v_mov_b32 v20, v16
    v_mov_b32 v22, v18
    s_nop 0
    v_max_f32_dpp v20, v20, v20 row_ror:4 row_mask:0xf bank_mask:0xf
    v_max_f32_dpp v22, v22, v22 row_ror:4 row_mask:0xf bank_mask:0xf
    s_nop 0
    v_max_f32_dpp v20, v20, v20 row_ror:8 row_mask:0xf bank_mask:0xf
    v_max_f32_dpp v22, v22, v22 row_ror:8 row_mask:0xf bank_mask:0xf
    v_mov_b32 v24, v20
    v_mov_b32 v25, v22
    s_nop 0
    v_permlane16_swap_b32 v24, v20
    v_permlane16_swap_b32 v25, v22
    v_max_f32 v20, v20, v24
    v_max_f32 v22, v22, v25
    v_mov_b32 v24, v20
    v_mov_b32 v25, v22
    s_nop 0
    v_permlane32_swap_b32 v24, v20
    v_permlane32_swap_b32 v25, v22
    v_max_f32 v20, v20, v24
    v_max_f32 v22, v22, v25
    v_sub_f32 v16, v16, v20
    v_sub_f32 v18, v18, v22
    v_exp_f32 v16, v16
    v_exp_f32 v18, v18
    v_mul_f32 v21, v16, v17
    v_mul_f32 v23, v18, v19
    s_nop 0
    v_add_f32_dpp v21, v21, v21 row_ror:4 row_mask:0xf bank_mask:0xf
    v_add_f32_dpp v23, v23, v23 row_ror:4 row_mask:0xf bank_mask:0xf
    s_nop 0
    v_add_f32_dpp v21, v21, v21 row_ror:8 row_mask:0xf bank_mask:0xf
    v_add_f32_dpp v23, v23, v23 row_ror:8 row_mask:0xf bank_mask:0xf
    v_mov_b32 v24, v21
    v_mov_b32 v25, v23
    s_nop 0
    v_permlane16_swap_b32 v24, v21
    v_permlane16_swap_b32 v25, v23
    v_add_f32 v21, v21, v24
    v_add_f32 v23, v23, v25
    v_mov_b32 v24, v21
    v_mov_b32 v25, v23
    s_nop 0
    v_permlane32_swap_b32 v24, v21
    v_permlane32_swap_b32 v25, v23
    v_add_f32 v21, v21, v24
    v_add_f32 v23, v23, v25
    v_rcp_f32 v21, v21
    v_rcp_f32 v23, v23
    v_add_u32 v24, 150016, v5
    s_mov_b64 exec, 15
    ds_write_b128 v24, v[20:23]
    s_waitcnt lgkmcnt(0)
    s_mov_b64 exec, -1
    s_mov_b64 exec, 1
    ds_add_u32 v2, v3 offset:84
    s_mov_b64 exec, -1
Lml_238_f:
    s_mov_b32 s41, 0
Lsp_261:
    ds_read_b32 v4, v2 offset:84
    s_add_u32 s41, s41, 1
    s_waitcnt lgkmcnt(0)
    v_readfirstlane_b32 s40, v4
    s_nop 0
    s_cmp_ge_u32 s40, 1
    s_nop 1
    s_cbranch_scc1 Lspd_262
    s_cmp_lt_u32 s41, 131072
    s_cbranch_scc1 Lsp_261
Lspd_262:
    ds_read_b64 v[20:21], v9
    s_waitcnt lgkmcnt(0)
    v_sub_f32 v192, v192, v20
    v_sub_f32 v193, v193, v20
    v_sub_f32 v194, v194, v20
    v_sub_f32 v195, v195, v20
    v_exp_f32 v192, v192
    v_exp_f32 v193, v193
    v_exp_f32 v194, v194
    v_exp_f32 v195, v195
    v_mul_f32 v192, v192, v21
    v_mul_f32 v193, v193, v21
    v_mul_f32 v194, v194, v21
    v_mul_f32 v195, v195, v21
    s_nop 0
    s_branch Lml_238
Lfd_247_s:
    s_mov_b32 s41, 0
Lg_263:
    buffer_load_dword v16, v57, s[44:47], s58 offen offset:0 sc1
    buffer_load_dwordx2 v[20:21], v58, s[44:47], s49 offen offset:0 sc1
    buffer_load_dwordx2 v[214:215], v212, s[44:47], s51 offen offset:0 sc1
    s_waitcnt vmcnt(0)
    v_max3_u32 v4, v16, v20, v21
    v_max3_u32 v4, v4, v214, v215
    v_cmp_eq_u32 vcc, -1, v4
    s_add_u32 s41, s41, 1
    s_cbranch_vccz Lgd_264
    s_mov_b64 exec, vcc
    s_sleep 1
    s_cmp_lt_u32 s41, 8192
    s_cbranch_scc1 Lg_263
Lgd_264:
    s_mov_b64 exec, -1
    v_lshlrev_b32 v204, 16, v214
    v_lshlrev_b32 v205, 16, v215
    v_and_b32 v206, 0xffff0000, v214
    v_and_b32 v207, 0xffff0000, v215
    v_lshlrev_b32 v32, 16, v16
    v_and_b32 v33, 0xffff0000, v16
    v_add_f32_dpp v20, v20, v20 row_ror:1 row_mask:0xf bank_mask:0xf
    v_add_f32_dpp v21, v21, v21 row_ror:1 row_mask:0xf bank_mask:0xf
    s_nop 0
    v_add_f32_dpp v20, v20, v20 row_ror:2 row_mask:0xf bank_mask:0xf
    v_add_f32_dpp v21, v21, v21 row_ror:2 row_mask:0xf bank_mask:0xf
    s_nop 0
    v_add_f32_dpp v20, v20, v20 row_ror:4 row_mask:0xf bank_mask:0xf
    v_add_f32_dpp v21, v21, v21 row_ror:4 row_mask:0xf bank_mask:0xf
    s_nop 0
    v_add_f32_dpp v20, v20, v20 row_ror:8 row_mask:0xf bank_mask:0xf
    v_add_f32_dpp v21, v21, v21 row_ror:8 row_mask:0xf bank_mask:0xf
    v_mul_f32 v20, 0x3a800000, v20
    v_mul_f32 v21, 0x3a800000, v21
    v_fma_f32 v21, -v20, v20, v21
    v_cmp_u_f32 s[42:43], v21, v21
    v_max_f32 v21, 0, v21
    v_add_f32 v21, 0x3727c5ac, v21
    v_rsq_f32 v21, v21
    v_sub_f32 v32, v32, v20
    v_sub_f32 v33, v33, v20
    v_mul_f32 v32, v32, v21
    v_mul_f32 v33, v33, v21
    v_fma_f32 v32, v32, v204, v206
    v_fma_f32 v33, v33, v205, v207
    v_cvt_pk_bf16_f32 v16, v32, v33
    ds_write_b32 v60, v16 offset:1280
    s_branch Lfd_247
Lfd_250_s:
    s_mov_b32 s41, 0
Lg_265:
    buffer_load_dwordx2 v[16:17], v55, s[44:47], s48 offen offset:0 sc1
    buffer_load_dwordx2 v[18:19], v55, s[44:47], s52 offen offset:0 sc1
    buffer_load_dwordx2 v[20:21], v55, s[44:47], s53 offen offset:0 sc1
    buffer_load_dwordx2 v[22:23], v55, s[44:47], s54 offen offset:0 sc1
    buffer_load_dwordx2 v[24:25], v55, s[44:47], s55 offen offset:0 sc1
    buffer_load_dwordx2 v[26:27], v55, s[44:47], s56 offen offset:0 sc1
    buffer_load_dwordx2 v[28:29], v55, s[44:47], s57 offen offset:0 sc1
    buffer_load_dwordx2 v[30:31], v55, s[44:47], s58 offen offset:0 sc1
    s_waitcnt vmcnt(0)
    v_max3_u32 v4, v16, v17, v18
    v_max3_u32 v4, v4, v19, v20
    v_max3_u32 v4, v4, v21, v22
    v_max3_u32 v4, v4, v23, v24
    v_max3_u32 v4, v4, v25, v26
    v_max3_u32 v4, v4, v27, v28
    v_max3_u32 v4, v4, v29, v30
    v_max_u32 v4, v4, v31
    v_cmp_eq_u32 vcc, -1, v4
    s_add_u32 s41, s41, 1
    s_cbranch_vccz Lgd_266
    s_mov_b64 exec, vcc
    s_sleep 1
    s_cmp_lt_u32 s41, 8192
    s_cbranch_scc1 Lg_265
Lgd_266:
    s_mov_b64 exec, -1
    v_lshlrev_b32 v32, 16, v16
    v_and_b32 v33, 0xffff0000, v16
    v_lshlrev_b32 v34, 16, v17
    v_and_b32 v35, 0xffff0000, v17
    v_dot2_f32_bf16 v32, v18, s61, v32
    v_dot2_f32_bf16 v33, v18, s62, v33
    v_dot2_f32_bf16 v34, v19, s61, v34
    v_dot2_f32_bf16 v35, v19, s62, v35
    v_dot2_f32_bf16 v32, v20, s61, v32
    v_dot2_f32_bf16 v33, v20, s62, v33
    v_dot2_f32_bf16 v34, v21, s61, v34
    v_dot2_f32_bf16 v35, v21, s62, v35
    v_dot2_f32_bf16 v32, v22, s61, v32
    v_dot2_f32_bf16 v33, v22, s62, v33
    v_dot2_f32_bf16 v34, v23, s61, v34
    v_dot2_f32_bf16 v35, v23, s62, v35
    v_dot2_f32_bf16 v32, v24, s61, v32
    v_dot2_f32_bf16 v33, v24, s62, v33
    v_dot2_f32_bf16 v34, v25, s61, v34
    v_dot2_f32_bf16 v35, v25, s62, v35
    v_dot2_f32_bf16 v32, v26, s61, v32
    v_dot2_f32_bf16 v33, v26, s62, v33
    v_dot2_f32_bf16 v34, v27, s61, v34
    v_dot2_f32_bf16 v35, v27, s62, v35
    v_dot2_f32_bf16 v32, v28, s61, v32
    v_dot2_f32_bf16 v33, v28, s62, v33
    v_dot2_f32_bf16 v34, v29, s61, v34
    v_dot2_f32_bf16 v35, v29, s62, v35
    v_dot2_f32_bf16 v32, v30, s61, v32
    v_dot2_f32_bf16 v33, v30, s62, v33
    v_dot2_f32_bf16 v34, v31, s61, v34
    v_dot2_f32_bf16 v35, v31, s62, v35
    s_nop 1
    s_branch Lfd_250
L_ts:
    s_sub_u32 s98, s99, 224
    s_lshl_b32 s98, s98, 1
    s_add_u32 s98, s98, s3
    s_sub_u32 s98, s98, 2
    v_bfe_u32 v13, v1, 2, 2
    v_and_b32 v14, 3, v1
    v_lshrrev_b32 v15, 4, v1
    v_mul_u32_u24 v8, 64, v13
    v_mul_u32_u24 v14, 16, v14
    v_mul_u32_u24 v15, 49664, v15
    v_add3_u32 v8, v8, v14, v15
    s_lshr_b32 s42, s98, 4
    s_mul_i32 s42, s42, 12416
    s_and_b32 s43, s98, 15
    s_lshl_b32 s43, s43, 8
    s_add_u32 s42, s42, s43
    s_add_u32 s12, s42, 2023424
    s_add_u32 s13, s12, 4096
    s_mov_b32 s41, 0
Lg_267:
    buffer_load_dwordx4 v[24:27], v8, s[44:47], s12 offen offset:0 sc1
    buffer_load_dwordx4 v[28:31], v8, s[44:47], s13 offen offset:0 sc1
    s_waitcnt vmcnt(0)
    v_max3_u32 v4, v24, v25, v26
    v_max3_u32 v4, v4, v27, v28
    v_max3_u32 v4, v4, v29, v30
    v_max_u32 v4, v4, v31
    v_cmp_eq_u32 vcc, -1, v4
    s_add_u32 s41, s41, 1
    s_cbranch_vccz Lgd_268
    s_mov_b64 exec, vcc
    s_sleep 1
    s_cmp_lt_u32 s41, 8192
    s_cbranch_scc1 Lg_267
Lgd_268:
    s_mov_b64 exec, -1
    v_permlane32_swap_b32 v24, v26
    v_permlane32_swap_b32 v25, v27
    v_pk_add_f32 v[24:25], v[24:25], v[26:27]
    v_mov_b32 v26, v24
    v_mov_b32 v27, v25
    s_nop 0
    v_permlane16_swap_b32 v26, v24
    v_permlane16_swap_b32 v27, v25
    v_pk_add_f32 v[24:25], v[24:25], v[26:27]
    v_permlane32_swap_b32 v28, v30
    v_permlane32_swap_b32 v29, v31
    v_pk_add_f32 v[28:29], v[28:29], v[30:31]
    v_mov_b32 v30, v28
    v_mov_b32 v31, v29
    s_nop 0
    v_permlane16_swap_b32 v30, v28
    v_permlane16_swap_b32 v31, v29
    v_pk_add_f32 v[28:29], v[28:29], v[30:31]
    v_cvt_pk_bf16_f32 v26, v28, v29
    v_lshlrev_b32 v28, 16, v26
    v_and_b32 v29, 0xffff0000, v26
    v_add_f32 v28, 1.0, v28
    v_add_f32 v29, 1.0, v29
    v_cvt_pk_bf16_f32 v24, v28, v24
    v_cvt_pk_bf16_f32 v25, v29, v25
    v_min_u32 v24, -2, v24
    v_min_u32 v25, -2, v25
    v_lshlrev_b32 v8, 1, v63
    s_lshl_b32 s40, s98, 8
    s_add_u32 s40, s40, 2381824
    s_mov_b32 s54, 0xffff
    s_mov_b32 s55, 0xffff
    s_mov_b64 exec, s[54:55]
    buffer_store_dwordx2 v[24:25], v8, s[44:47], s40 offen sc1
    s_mov_b64 exec, -1
    s_branch L_fin
Lfd_254_s:
    s_mov_b32 s41, 0
Lg_269:
    buffer_load_dwordx4 v[16:19], v5, s[44:47], s40 offen offset:0 sc1
    buffer_load_dwordx4 v[20:23], v5, s[44:47], s40 offen offset:1024 sc1
    buffer_load_dwordx4 v[24:27], v5, s[44:47], s40 offen offset:2048 sc1
    buffer_load_dwordx4 v[28:31], v5, s[44:47], s40 offen offset:3072 sc1
    buffer_load_dwordx4 v[32:35], v5, s[44:47], s51 offen offset:0 sc1
    buffer_load_dwordx4 v[36:39], v5, s[44:47], s51 offen offset:1024 sc1
    buffer_load_dwordx4 v[40:43], v5, s[44:47], s51 offen offset:2048 sc1
    buffer_load_dwordx4 v[44:47], v5, s[44:47], s51 offen offset:3072 sc1
    s_waitcnt vmcnt(0)
    v_max3_u32 v4, v16, v17, v18
    v_max3_u32 v4, v4, v19, v20
    v_max3_u32 v4, v4, v21, v22
    v_max3_u32 v4, v4, v23, v24
    v_max3_u32 v4, v4, v25, v26
    v_max3_u32 v4, v4, v27, v28
    v_max3_u32 v4, v4, v29, v30
    v_max3_u32 v4, v4, v31, v32
    v_max3_u32 v4, v4, v33, v34
    v_max3_u32 v4, v4, v35, v36
    v_max3_u32 v4, v4, v37, v38
    v_max3_u32 v4, v4, v39, v40
    v_max3_u32 v4, v4, v41, v42
    v_max3_u32 v4, v4, v43, v44
    v_max3_u32 v4, v4, v45, v46
    v_max_u32 v4, v4, v47
    v_cmp_eq_u32 vcc, -1, v4
    s_add_u32 s41, s41, 1
    s_cbranch_vccz Lgd_270
    s_mov_b64 exec, vcc
    s_sleep 1
    s_cmp_lt_u32 s41, 8192
    s_cbranch_scc1 Lg_269
Lgd_270:
    s_mov_b64 exec, -1
    v_pk_add_f32 v[16:17], v[16:17], v[20:21]
    v_pk_add_f32 v[18:19], v[18:19], v[22:23]
    v_pk_add_f32 v[16:17], v[16:17], v[24:25]
    v_pk_add_f32 v[18:19], v[18:19], v[26:27]
    v_pk_add_f32 v[16:17], v[16:17], v[28:29]
    v_pk_add_f32 v[18:19], v[18:19], v[30:31]
    v_pk_add_f32 v[16:17], v[16:17], v[32:33]
    v_pk_add_f32 v[18:19], v[18:19], v[34:35]
    v_pk_add_f32 v[16:17], v[16:17], v[36:37]
    v_pk_add_f32 v[18:19], v[18:19], v[38:39]
    v_pk_add_f32 v[16:17], v[16:17], v[40:41]
    v_pk_add_f32 v[18:19], v[18:19], v[42:43]
    v_pk_add_f32 v[16:17], v[16:17], v[44:45]
    v_pk_add_f32 v[18:19], v[18:19], v[46:47]
    s_nop 1
    v_permlane32_swap_b32 v16, v18
    v_permlane32_swap_b32 v17, v19
    v_pk_add_f32 v[16:17], v[16:17], v[18:19]
    v_mov_b32 v18, v16
    v_mov_b32 v19, v17
    s_nop 0
    v_permlane16_swap_b32 v18, v16
    v_permlane16_swap_b32 v19, v17
    v_pk_add_f32 v[16:17], v[16:17], v[18:19]
    s_nop 0
    s_branch Lfd_254
Lfd_258_s:
    s_mov_b32 s41, 0
Lg_271:
    buffer_load_dwordx4 v[16:19], v5, s[44:47], s40 offen offset:0 sc1
    buffer_load_dwordx4 v[20:23], v5, s[44:47], s40 offen offset:1024 sc1
    buffer_load_dwordx4 v[24:27], v5, s[44:47], s40 offen offset:2048 sc1
    buffer_load_dwordx4 v[28:31], v5, s[44:47], s40 offen offset:3072 sc1
    buffer_load_dwordx4 v[32:35], v5, s[44:47], s51 offen offset:0 sc1
    buffer_load_dwordx4 v[36:39], v5, s[44:47], s51 offen offset:1024 sc1
    buffer_load_dwordx4 v[40:43], v5, s[44:47], s51 offen offset:2048 sc1
    s_waitcnt vmcnt(0)
    v_max3_u32 v4, v16, v17, v18
    v_max3_u32 v4, v4, v19, v20
    v_max3_u32 v4, v4, v21, v22
    v_max3_u32 v4, v4, v23, v24
    v_max3_u32 v4, v4, v25, v26
    v_max3_u32 v4, v4, v27, v28
    v_max3_u32 v4, v4, v29, v30
    v_max3_u32 v4, v4, v31, v32
    v_max3_u32 v4, v4, v33, v34
    v_max3_u32 v4, v4, v35, v36
    v_max3_u32 v4, v4, v37, v38
    v_max3_u32 v4, v4, v39, v40
    v_max3_u32 v4, v4, v41, v42
    v_max_u32 v4, v4, v43
    v_cmp_eq_u32 vcc, -1, v4
    s_add_u32 s41, s41, 1
    s_cbranch_vccz Lgd_272
    s_mov_b64 exec, vcc
    s_sleep 1
    s_cmp_lt_u32 s41, 8192
    s_cbranch_scc1 Lg_271
Lgd_272:
    s_mov_b64 exec, -1
    v_pk_add_f32 v[16:17], v[16:17], v[20:21]
    v_pk_add_f32 v[18:19], v[18:19], v[22:23]
    v_pk_add_f32 v[16:17], v[16:17], v[24:25]
    v_pk_add_f32 v[18:19], v[18:19], v[26:27]
    v_pk_add_f32 v[16:17], v[16:17], v[28:29]
    v_pk_add_f32 v[18:19], v[18:19], v[30:31]
    v_pk_add_f32 v[16:17], v[16:17], v[32:33]
    v_pk_add_f32 v[18:19], v[18:19], v[34:35]
    v_pk_add_f32 v[16:17], v[16:17], v[36:37]
    v_pk_add_f32 v[18:19], v[18:19], v[38:39]
    v_pk_add_f32 v[16:17], v[16:17], v[40:41]
    v_pk_add_f32 v[18:19], v[18:19], v[42:43]
    s_nop 1
    v_permlane32_swap_b32 v16, v18
    v_permlane32_swap_b32 v17, v19
    v_pk_add_f32 v[16:17], v[16:17], v[18:19]
    v_mov_b32 v18, v16
    v_mov_b32 v19, v17
    s_nop 0
    v_permlane16_swap_b32 v18, v16
    v_permlane16_swap_b32 v19, v17
    v_pk_add_f32 v[16:17], v[16:17], v[18:19]
    s_nop 0
    s_branch Lfd_258
L_exit:
    s_endpgm
.p2align 8
.type role_table,@object
role_table:
.long 256, 20448256, 15211520, 12288
.long 256, 1104, 12660256, 8192
.long 3145984, 20514064, 15356984, 12288
.long 2097408, 1392, 9134680, 8192
.long 6291712, 20579872, 16027248, 12288
.long 4194560, 1680, 8755856, 8192
.long 2816, 11432, 11972776, 8192
.long 9984, 40152, 6804424, 12288
.long 9437440, 20645633, 15736321, 12288
.long 6291712, 1873, 13184801, 8192
.long 1280, 20714513, 15881785, 12288
.long 1280, 5233, 9659225, 8192
.long 3147008, 20780321, 16551793, 12288
.long 2098432, 5521, 9280401, 8192
.long 2099968, 11689, 12497577, 8192
.long 3155712, 40409, 7328969, 12288
.long 6292736, 20846082, 16260866, 12288
.long 4195584, 5714, 13709346, 8192
.long 9438464, 20911890, 16406330, 12288
.long 6292736, 6002, 10183770, 8192
.long 2304, 9250, 2388338, 12288
.long 2304, 9362, 9804946, 8192
.long 4197120, 11946, 439210, 8192
.long 6301440, 40666, 7853770, 12288
.long 3148032, 9475, 3670275, 12288
.long 2099456, 9555, 14234147, 8192
.long 6293760, 9747, 2242875, 12288
.long 4196608, 9843, 12805723, 8192
.long 9439488, 10019, 2913651, 12288
.long 6293760, 10131, 10329747, 8192
.long 6294272, 12203, 963755, 8192
.long 9447168, 40923, 8378315, 12288
.long 3328, 13316, 10487044, 12288
.long 3328, 13396, 14758692, 8192
.long 3149056, 13588, 2768188, 12288
.long 2100480, 13684, 13330268, 8192
.long 6294784, 13860, 3438964, 12288
.long 4197632, 13972, 12951444, 8192
.long 3072, 12460, 1488556, 8192
.long 9728, 39132, 8902860, 12288
.long 9440512, 14085, 11012357, 12288
.long 6294784, 14165, 15283237, 8192
.long 0, 17301525, 672317, 12288
.long 4352, 17525, 13854813, 8192
.long 3145728, 17367333, 1866613, 12288
.long 2101504, 17813, 13475989, 8192
.long 2100224, 12717, 2013101, 8192
.long 3155456, 39389, 9427661, 12288
.long 6291456, 17433094, 5246726, 12288
.long 4198656, 18006, 15808038, 8192
.long 9437184, 17498902, 1196862, 12288
.long 6295808, 18294, 14379614, 8192
.long 512, 17565734, 4488310, 12288
.long 5376, 21654, 14000790, 8192
.long 4197376, 12974, 4634798, 8192
.long 6301184, 39646, 9952206, 12288
.long 3146240, 17631495, 5771271, 12288
.long 2102528, 21847, 16332583, 8192
.long 6291968, 17697303, 1721407, 12288
.long 4199680, 22135, 14904159, 8192
.long 9437696, 17763111, 5013111, 12288
.long 6296832, 22423, 14525335, 8192
.long 6294528, 13231, 5159599, 8192
.long 9446912, 39903, 10476751, 12288
.long 3584, 14408, 11535368, 8192
.long 9216, 37056, 1123112, 12288
.long 768, 19401752, 4343360, 12288
.long 6400, 25720, 15428704, 8192
.long 3146496, 19467560, 5537656, 12288
.long 2103552, 26008, 15049880, 8192
.long 6292224, 19533360, 5684144, 12288
.long 4200704, 26288, 16244432, 8192
.long 2100736, 14665, 12060169, 8192
.long 3154944, 37313, 1647657, 12288
.long 9437952, 19599129, 4867905, 12288
.long 6297856, 26489, 15953505, 8192
.long 1024, 19664937, 6062201, 12288
.long 7424, 29849, 15574681, 8192
.long 3146752, 19730737, 6208689, 12288
.long 2104576, 30129, 16768977, 8192
.long 4197888, 14922, 1802, 8192
.long 6300672, 37570, 4269610, 12288
.long 6292480, 19796506, 5392450, 12288
.long 4201728, 30330, 16478050, 8192
.long 9438208, 19862314, 6587002, 12288
.long 6298880, 30618, 16099226, 8192
.long 1536, 16783410, 6728114, 12288
.long 0, 178, 13093330, 8192
.long 6295040, 15179, 526347, 8192
.long 9446400, 37827, 4794155, 12288
.long 3147264, 16849179, 5914947, 12288
.long 2097152, 379, 5986659, 8192
.long 6292992, 16914987, 7110011, 12288
.long 4194304, 667, 364955, 8192
.long 9438720, 16980787, 7253427, 12288
.long 6291456, 947, 13618643, 8192
.long 3840, 15436, 1051148, 8192
.long 8960, 36036, 5318700, 12288
.long 1792, 17046556, 6440260, 12288
.long 512, 2172, 6511972, 8192
.long 3147520, 17112364, 7635324, 12288
.long 2097664, 2460, 890268, 8192
.long 6293248, 17178164, 7778740, 12288
.long 4194816, 2740, 14143956, 8192
.long 2100992, 15693, 1575693, 8192
.long 3154688, 36293, 5843501, 12288
.long 9438976, 17243933, 6965573, 12288
.long 6291968, 2941, 7037285, 8192
.long 2048, 17834029, 8160637, 12288
.long 768, 3229, 1415581, 8192
.long 3147776, 17899829, 8304053, 12288
.long 2097920, 3509, 14669269, 8192
.long 4198144, 15950, 4197390, 8192
.long 6300416, 36550, 6368046, 12288
.long 6293504, 17965598, 7490886, 12288
.long 4195072, 3710, 7562598, 8192
.long 9439232, 18031406, 8685950, 12288
.long 6292224, 3998, 1940894, 8192
.long 2560, 18098230, 8829366, 12288
.long 1024, 4278, 15194582, 8192
.long 6295296, 16207, 4722191, 8192
.long 9446144, 36807, 6892591, 12288
.long 3148288, 18163999, 8016199, 12288
.long 2098176, 4479, 8087911, 8192
.long 6294016, 18229807, 9211263, 12288
.long 4195328, 4767, 4563359, 8192
.long 9439744, 18295607, 9354679, 12288
.long 6292480, 5047, 15719895, 8192
.long 2816, 18361352, 6294800, 12288
.long 1536, 6232, 7414064, 8192
.long 4096, 16488, 14832968, 8192
.long 8704, 35016, 8613224, 12288
.long 5632, 1073764480, 9732992, 8192
.long 7936, 19954896, 16623008, 12288
.long 3148544, 18427192, 9879992, 12288
.long 2098688, 6584, 510168, 8192
.long 6294272, 18492937, 6820113, 12288
.long 4195840, 6745, 7939377, 8192
.long 2101248, 16745, 3291209, 8192
.long 3154432, 35273, 219241, 12288
.long 2102784, 1107319169, 10257537, 8192
.long 3153664, 20020689, 5083297, 12288
.long 9440000, 18558777, 10405305, 12288
.long 6292992, 7097, 1034969, 8192
.long 3072, 18624522, 7345426, 12288
.long 1792, 7258, 8464690, 8192
.long 4198400, 17002, 3816010, 8192
.long 6300160, 35530, 744042, 12288
.long 4199936, 1140873858, 12879490, 8192
.long 6299392, 20086482, 5608098, 12288
.long 3148800, 18690362, 2533562, 12288
.long 2098944, 7610, 1559514, 8192
.long 6294528, 18756107, 7870739, 12288
.long 4196096, 7771, 8990003, 8192
.long 6295552, 17259, 10632011, 8192
.long 9445888, 35787, 1268587, 12288
.long 6297088, 1174428547, 13404035, 8192
.long 9445120, 20152275, 6132643, 12288
.long 9440256, 18821947, 3058363, 12288
.long 6293248, 8123, 2084059, 8192
.long 3584, 18888716, 8396052, 12288
.long 2048, 8284, 9515316, 8192
.long 4608, 18540, 11156556, 8192
.long 8192, 32972, 1793132, 12288
.long 5888, 1207983236, 13928580, 8192
.long 7680, 20216020, 6657188, 12288
.long 3149312, 18954556, 3582908, 12288
.long 2099200, 8636, 4706012, 8192
.long 6295040, 19020301, 2097173, 12288
.long 4196352, 8797, 10040629, 8192
.long 2101760, 18797, 11681357, 8192
.long 3153920, 33229, 4415085, 12288
.long 2103040, 1241537925, 14453381, 8192
.long 3153408, 20281813, 7181989, 12288
.long 9440768, 19086141, 4107453, 12288
.long 6293504, 9149, 5230557, 8192
.long 3840, 19151886, 2621974, 12288
.long 2560, 10334, 73782, 8192
.long 4198912, 19054, 12205902, 8192
.long 6299648, 33486, 4939630, 12288
.long 4200192, 1275092614, 14977926, 8192
.long 6299136, 20347606, 7706534, 12288
.long 3149568, 19217726, 10923710, 12288
.long 2099712, 10686, 5755102, 8192
.long 6295296, 19283471, 3146519, 12288
.long 4196864, 10847, 598583, 8192
.long 6296064, 19311, 147535, 8192
.long 9445376, 33743, 5464175, 12288
.long 6297344, 1308647303, 15502471, 8192
.long 9444864, 20413399, 8231079, 12288
.long 9441024, 19349311, 11448255, 12288
.long 6294016, 11199, 6279903, 8192
.long 6144, 1342201920, 8917528, 8192
.long 7168, 2453728, 3211264, 12288
.long 2103296, 1375756640, 8538704, 8192
.long 3152896, 2453985, 3342336, 12288
.long 4864, 19592, 3960968, 8192
.long 6298624, 2454242, 3473408, 12288
.long 4200448, 1409311392, 13024960, 8192
.long 9444352, 2454499, 3604480, 12288
.long 6297600, 1442865985, 9442073, 8192
.long 6912, 2190564, 3735552, 12288
.long 6656, 1476421729, 9063249, 8192
.long 3152640, 2190821, 3866624, 12288
.long 2102016, 19849, 10777225, 8192
.long 6298368, 2191078, 3997696, 12288
.long 2103808, 1509976481, 13549505, 8192
.long 9444096, 2191335, 4128768, 12288
.long 4200960, 1543531074, 9966618, 8192
.long 6656, 1927400, 10551296, 12288
.long 6298112, 1577085794, 9587794, 8192
.long 3152384, 1927657, 10682368, 12288
.long 4199168, 20106, 11301770, 8192
.long 6298112, 1927914, 10813440, 12288
.long 6912, 1610640546, 14074050, 8192
.long 9443840, 1928171, 10944512, 12288
.long 2104064, 1644195139, 12588571, 8192
.long 6144, 1663212, 11075584, 12288
.long 4201216, 1677749859, 10112595, 8192
.long 3151872, 1663469, 11206656, 12288
.long 6296320, 20363, 11826315, 8192
.long 6297600, 1663726, 11337728, 12288
.long 6298368, 1711304611, 14598851, 8192
.long 9443328, 1663983, 11468800, 12288
.long 7168, 1744859204, 13113116, 8192
.long 5888, 1400048, 11599872, 12288
.long 2104320, 1778413924, 12734292, 8192
.long 3151616, 1400305, 11730944, 12288
.long 5120, 20620, 12351116, 8192
.long 6297344, 1400562, 11862016, 12288
.long 4201472, 1811968676, 15123396, 8192
.long 9443072, 1400819, 11993088, 12288
.long 6298624, 1845523269, 13637661, 8192
.long 5632, 1136884, 12124160, 12288
.long 7680, 1879079013, 13258837, 8192
.long 3151360, 1137141, 12255232, 12288
.long 2102272, 20877, 292749, 8192
.long 6297088, 1137398, 12386304, 12288
.long 2104832, 1912633765, 15647941, 8192
.long 9442816, 1137655, 12517376, 12288
.long 4201984, 1946188358, 14162462, 8192
.long 5120, 1265912, 2162688, 12288
.long 6299136, 1979743078, 13783638, 8192
.long 3150848, 1266169, 2293760, 12288
.long 4199424, 21134, 817294, 8192
.long 6296576, 1266426, 2424832, 12288
.long 7936, 2013297830, 16172742, 8192
.long 9442304, 1266683, 2555904, 12288
.long 2105088, 2046852423, 14687007, 8192
.long 4608, 1067260, 2686976, 12288
.long 4202240, 2080407143, 14308183, 8192
.long 3150336, 1067517, 2818048, 12288
.long 6296576, 21391, 1342095, 8192
.long 6296064, 1067774, 2949120, 12288
.long 6299392, 2113961895, 16697287, 8192
.long 9441792, 1068031, 3080192, 12288
.size role_table, 4096
.p2align 8
.fill (40960+256-(.-adaLN_cond__gqa_block_cached__glu_gated_swiglu__decode_kernel))/4, 4, 0xbf800000
.section .rodata,"a"
.p2align 6
.amdhsa_kernel adaLN_cond__gqa_block_cached__glu_gated_swiglu__decode_kernel
  .amdhsa_next_free_vgpr 256
  .amdhsa_next_free_sgpr 102
  .amdhsa_accum_offset 256
  .amdhsa_group_segment_fixed_size 0
  .amdhsa_kernarg_size 112
  .amdhsa_user_sgpr_count 2
  .amdhsa_user_sgpr_kernarg_segment_ptr 1
  .amdhsa_system_sgpr_workgroup_id_x 1
  .amdhsa_float_denorm_mode_32 3
.end_amdhsa_kernel
```
